```python
import torch

def _softmax(x, axis=-1):
    return torch.softmax(x, dim=axis)
def _gelu(x):
    return torch.nn.functional.gelu(x, approximate="tanh")
def _silu(x):
    return torch.nn.functional.silu(x)
def _sigmoid(x):
    return torch.sigmoid(x)
def _layernorm(x, axis=-1, eps=1e-5):
    m = x.mean(dim=axis, keepdim=True)
    v = x.var(dim=axis, keepdim=True, unbiased=False)
    return (x - m) / torch.sqrt(v + eps)
def _scatter_add(tgt, idx, src, axis=0):
    return tgt.clone().index_add_(axis, idx, src)
def _segment_sum(src, seg, n):
    out = torch.zeros((n,) + src.shape[1:], dtype=src.dtype)
    return out.index_add_(0, seg, src)
def _pad(x, pw):
    flat = tuple(v for pair in reversed(pw) for v in pair)
    return torch.nn.functional.pad(x, flat)

kernel_name = 'standalone__paged_block_table_kv_pagedattention__sampling'

def setup_inputs():

    _w = (lambda a: (lambda t: t.to(torch.bfloat16) if t.is_floating_point() else t)(torch.as_tensor(a)))
    B, Hq, Hkv, Sq, Skv, D = 16, 32, 8, 32, 4096, 128
    bs = 16
    nbps = max(1, Skv // bs)
    num_phys = B * nbps + 4
    bt = torch.randperm(num_phys)[: B * nbps].reshape(B, nbps).to(torch.int64)
    cl = (nbps * bs - (torch.arange(1, B + 1, dtype=torch.int64) * 2654435761) % max(1, nbps * bs // 2)).to(torch.int64)
    return {
        "q": _w((lambda *s: torch.randn(*s, dtype=torch.bfloat16) * 0.8)(B, Hq, Sq, D)),
        "k_cache": _w((lambda *s: torch.randn(*s, dtype=torch.bfloat16) * 0.8)(num_phys, bs, Hkv, D)),
        "v_cache": _w((lambda *s: torch.randn(*s, dtype=torch.bfloat16) * 0.05)(num_phys, bs, Hkv, D)),
        "block_table": _w(bt),
        "context_lens": _w(cl),
    }

def reference(q, k_cache, v_cache, block_table, context_lens):
    B, Hq, Sq, D = q.shape
    bs = k_cache.shape[1]
    Hkv = k_cache.shape[2]
    nbps = block_table.shape[1]
    Skv = nbps * bs
    bt = block_table.reshape(-1)
    k = (lambda x, *d: x.permute(*d))(k_cache[bt].reshape(B, Skv, Hkv, D), 0, 2, 1, 3)
    v = (lambda x, *d: x.permute(*d))(v_cache[bt].reshape(B, Skv, Hkv, D), 0, 2, 1, 3)
    g = Hq // Hkv
    qg = q.reshape(B, Hkv, g, Sq, D)
    scores = torch.einsum("bhgqd,bhkd->bhgqk", qg, k) * (D ** -0.5)
    pos = torch.arange(Skv)
    msk = pos[None, :] < context_lens[:, None]
    scores = torch.where(msk[:, None, None, None, :], scores, -1e9)
    p = _softmax(scores, axis=-1)
    out = torch.einsum("bhgqk,bhkd->bhgqd", p, v)
    return out.reshape(B, Hq, Sq, D)
```

```asm
; @launch grid=(256,1,1) block=(448,1,1) lds=163328
.amdgcn_target "amdgcn-amd-amdhsa--gfx950"
.text
.globl standalone__paged_block_table_kv_pagedattention__sampling_kernel
.p2align 8
.type standalone__paged_block_table_kv_pagedattention__sampling_kernel,@function
standalone__paged_block_table_kv_pagedattention__sampling_kernel:
    s_cmp_ge_u32 s2, 256
    s_cbranch_scc1 L_end
    s_load_dwordx16 s[48:63], s[0:1], 0
    v_lshrrev_b32 v2, 6, v0
    v_and_b32 v1, 63, v0
    v_readfirstlane_b32 s3, v2
    s_getpc_b64 s[4:5]
L_pc:
    s_and_b32 s6, s2, 248
    v_subrev_u32 v3, 384, v0
    v_cmp_gt_u32 vcc, 8, v3
    v_add_u32 v3, s6, v3
    v_lshlrev_b32 v3, 7, v3
    v_min_u32 v3, L_code_end-L_pc-4, v3
    s_and_saveexec_b64 s[6:7], vcc
    s_cbranch_execz L_nocp
    global_load_dword v255, v3, s[4:5]
L_nocp:
    s_mov_b64 exec, s[6:7]
    v_lshlrev_b32 v239, 4, v1
    s_and_b32 s32, s2, 7
    s_lshr_b32 s33, s2, 6
    s_lshr_b32 s73, s2, 1
    s_and_b32 s73, s73, 28
    s_lshr_b32 s35, 0x1fa50e94, s73
    s_lshr_b32 s36, 0x6b27c38d, s73
    s_and_b32 s35, s35, 15
    s_and_b32 s36, s36, 15
    s_lshl_b32 s73, s35, 2
    s_lshl_b32 s74, s36, 2
    s_lshl_b32 s75, s35, 10
    s_lshl_b32 s76, s36, 10
    v_add_u32 v4, s75, v239
    v_add_u32 v5, s76, v239
    s_mov_b32 s46, 0x400000
    s_and_b32 s44, s2, 63
    s_cmp_lt_u32 s33, 2
    s_cselect_b32 s47, 4096, 0
    v_min_u32 v14, 383, v0
    v_lshlrev_b32 v14, 2, v14
    v_add_u32 v14, 156672, v14
    v_mov_b32 v238, 0
    ds_write_b32 v14, v238
    ds_write_b32 v14, v238 offset:1536
    v_mov_b32 v13, 157696
    v_lshrrev_b32 v2, 4, v1
    v_and_b32 v3, 15, v1
    v_xor_b32 v248, v3, v2
    v_lshlrev_b32 v248, 4, v248
    v_lshl_add_u32 v242, v2, 8, v248
    s_and_b32 s77, s32, 3
    s_cmp_eq_u32 s77, 1
    s_cselect_b32 s34, 22, 60
    s_mov_b32 s78, 0xff00ff00
    s_cselect_b32 s78, 0xff00e000, s78
    s_lshr_b32 s77, s2, 3
    s_bitcmp1_b32 s78, s77
    s_cselect_b32 s64, s36, s35
    s_mul_i32 s81, s3, 8704
    s_add_u32 s81, s81, 121856
    s_mov_b32 s10, 4194304
    s_mov_b32 s11, 0x20000
    s_lshl_b32 s77, s64, 3
    s_add_u32 s77, s77, s32
    s_lshl_b32 s77, s77, 2
    s_add_u32 s77, s77, s3
    s_lshl_b32 s77, s77, 13
    s_add_u32 s77, s77, s47
    s_xor_b32 s78, s77, 4096
    s_mov_b32 m0, 159744
    s_and_b32 s75, s3, 6
    s_cmp_eq_u32 s75, 4
    s_waitcnt lgkmcnt(0)
    s_cbranch_scc0 L_notab
    global_load_lds_dwordx4 v4, s[54:55]
    s_mov_b32 m0, 160768
    s_setprio 3
    global_load_lds_dwordx4 v5, s[54:55]
L_notab:
    s_load_dword s37, s[56:57], s73
    s_load_dword s38, s[56:57], s74
    s_mov_b32 s8, s48
    s_mov_b32 s9, s49
    s_cmp_lt_u32 s3, 4
    s_barrier
    s_cbranch_scc0 L_noq
    s_add_u32 m0, s81, 0
    s_nop 0
    buffer_load_dwordx4 v242, s[8:11], s77 offen offset:0 nt lds
    s_add_u32 m0, s81, 64
    s_nop 0
    buffer_load_dwordx4 v242, s[8:11], s77 offen offset:1024 nt lds
    s_add_u32 m0, s81, 128
    s_nop 0
    buffer_load_dwordx4 v242, s[8:11], s77 offen offset:2048 nt lds
    s_add_u32 m0, s81, 192
    s_nop 0
    buffer_load_dwordx4 v242, s[8:11], s77 offen offset:3072 nt lds
    s_add_u32 m0, s81, 4352
    s_nop 0
    buffer_load_dwordx4 v242, s[8:11], s78 offen offset:0 nt lds
    s_add_u32 m0, s81, 4416
    s_nop 0
    buffer_load_dwordx4 v242, s[8:11], s78 offen offset:1024 nt lds
    s_add_u32 m0, s81, 4480
    s_nop 0
    buffer_load_dwordx4 v242, s[8:11], s78 offen offset:2048 nt lds
    s_add_u32 m0, s81, 4544
    s_nop 0
    buffer_load_dwordx4 v242, s[8:11], s78 offen offset:3072 nt lds
L_noq:
    s_mov_b32 s12, s50
    s_mov_b32 s13, s51
    s_mov_b32 s14, 134348800
    s_mov_b32 s15, 0x20000
    s_mov_b32 s16, s52
    s_mov_b32 s17, s53
    s_mov_b32 s18, 134348800
    s_mov_b32 s19, 0x20000
    s_mov_b32 s20, s62
    s_mov_b32 s21, s63
    s_mov_b32 s22, 537395200
    s_mov_b32 s23, 0x20000
    s_mov_b32 s24, s58
    s_mov_b32 s25, s59
    s_mov_b32 s26, 4194304
    s_mov_b32 s27, 0x20000
    s_mov_b32 s28, s60
    s_mov_b32 s29, s61
    s_mov_b32 s30, 256
    s_mov_b32 s31, 0x20000
    s_mul_i32 s77, s44, 6
    s_add_u32 s77, s77, 0
    s_mul_i32 s77, s77, 17408
    v_lshrrev_b32 v4, 2, v1
    v_min_u32 v4, 5, v4
    v_mul_u32_u24 v4, 17408, v4
    v_and_b32 v5, 3, v1
    v_lshl_add_u32 v92, v5, 7, v4
    s_add_u32 s77, s77, 16896
    v_add_u32 v92, s77, v92
    s_cmp_eq_u32 s3, 5
    s_cbranch_scc0 L_nosnap
    buffer_load_dword v89, v92, s[20:23], 0 offen sc1
    v_add_u32 v4, 162304, v239
    v_mov_b32 v68, 0
    v_mov_b32 v69, 0
    v_mov_b32 v70, 0
    v_mov_b32 v71, 0
    ds_write_b128 v4, v[68:71]
L_nosnap:
    v_and_b32 v87, 3, v1
    v_lshlrev_b32 v87, 8, v87
    v_add_u32 v87, 156672, v87
    s_lshl_b32 s77, s32, 8
    v_lshl_add_u32 v4, v2, 11, v248
    v_add_u32 v76, s77, v4
    v_and_b32 v4, 1, v2
    v_lshlrev_b32 v4, 1, v4
    v_xor_b32 v4, v4, v3
    v_lshlrev_b32 v4, 4, v4
    v_lshl_add_u32 v4, v2, 13, v4
    v_add_u32 v80, s77, v4
    v_add_u32 v77, 7104, v76
    v_add_u32 v81, 960, v80
    v_add_u32 v78, 14208, v76
    v_add_u32 v82, 1920, v80
    v_add_u32 v79, 21312, v76
    v_add_u32 v83, 2880, v80
    s_waitcnt lgkmcnt(0)
    s_min_i32 s73, s37, 0x1000
    s_cmp_lt_i32 s73, 1
    s_cselect_b32 s73, 0x1000, s73
    s_cselect_b32 s75, 1, 0
    s_min_i32 s74, s38, 0x1000
    s_cmp_lt_i32 s74, 1
    s_cselect_b32 s74, 0x1000, s74
    s_cselect_b32 s76, 1, 0
    s_mov_b32 s77, s35
    s_cmp_lt_u32 s73, s74
    s_cselect_b32 s45, 1, 0
    s_cselect_b32 s37, s74, s73
    s_cselect_b32 s38, s73, s74
    s_cselect_b32 s35, s36, s35
    s_cselect_b32 s36, s77, s36
    s_cselect_b32 s43, s76, s75
    s_cselect_b32 s76, s75, s76
    s_lshl_b32 s76, s76, 1
    s_or_b32 s43, s43, s76
    s_cmp_eq_u32 s33, 3
    s_cselect_b32 s41, s38, s37
    s_sub_u32 s41, s41, 1
    s_and_b32 s41, s41, 31
    s_add_u32 s41, s41, 1
    s_add_u32 s39, s37, 31
    s_lshr_b32 s39, s39, 5
    s_add_u32 s40, s38, 31
    s_lshr_b32 s40, s40, 5
    s_add_u32 s73, s39, s40
    s_add_u32 s73, s73, 2
    s_lshr_b32 s73, s73, 2
    s_max_u32 s73, s73, 1
    s_min_u32 s37, s73, s39
    s_min_u32 s38, s73, s40
    s_add_u32 s75, s39, 1
    s_lshr_b32 s75, s75, 1
    s_add_u32 s76, s40, 1
    s_lshr_b32 s76, s76, 1
    s_sub_u32 s73, s39, s40
    s_cmp_le_u32 s73, s34
    s_cselect_b32 s37, s75, s37
    s_cselect_b32 s38, s76, s38
    s_cselect_b32 s78, 0x1000, 2
    s_sub_u32 s75, s39, s37
    s_sub_u32 s76, s40, s38
    s_add_u32 s74, s75, s76
    s_add_u32 s74, s74, 1
    s_lshr_b32 s74, s74, 1
    s_min_u32 s74, s74, s75
    s_sub_u32 s42, s75, s74
    s_cmp_le_u32 s42, s78
    s_cselect_b32 s74, s75, s74
    s_cselect_b32 s42, 0, s42
    s_cmp_ge_u32 s33, 2
    s_cbranch_scc1 L_plan_top
    s_mov_b32 s41, 32
    s_mov_b32 s40, s76
    s_mov_b32 s38, s76
    s_cmp_eq_u32 s33, 0
    s_cselect_b32 s37, s74, s42
    s_cselect_b32 s39, s74, s75
L_plan_top:
    s_bitcmp1_b32 s33, 0
    s_cselect_b32 s38, s38, 0
    s_cselect_b32 s42, 0, s42
    s_cmp_eq_u32 s33, 3
    s_cselect_b32 s37, 0, s37
    s_cmp_lt_u32 s3, 4
    s_cbranch_scc1 L_consumer
    s_cmp_eq_u32 s3, 6
    s_cbranch_scc1 L_pacer
    s_sub_u32 s73, s3, 4
    s_mul_i32 s73, s73, 4
    v_add_u32 v74, s73, v1
    s_add_u32 s65, s37, s38
    s_add_u32 s74, s40, s37
    v_cmp_gt_u32 vcc, s37, v74
    v_mov_b32 v4, s39
    v_mov_b32 v5, s74
    s_lshl_b32 s73, s45, 10
    s_add_u32 s73, s73, 159744
    v_cndmask_b32 v4, v5, v4, vcc
    s_lshl_b32 s74, s45, 10
    s_sub_u32 s74, 160768, s74
    v_xad_u32 v4, v74, -1, v4
    v_mov_b32 v5, s73
    v_mov_b32 v72, s74
    v_and_b32 v4, 127, v4
    v_cndmask_b32 v5, v72, v5, vcc
    v_lshl_add_u32 v4, v4, 3, v5
    s_cmp_eq_u32 s3, 5
    s_cbranch_scc1 L_helper
    s_cmp_eq_u32 s65, 0
    s_cbranch_scc1 L_ldone
    s_waitcnt vmcnt(0)
    ds_read_b64 v[72:73], v4
    s_mov_b32 s66, 1
    s_mov_b32 s67, 17408
    s_mov_b32 s68, 0
    s_mov_b32 s69, 7
    s_cmp_le_u32 s41, 16
    s_mov_b32 s70, 1
    s_mov_b32 s41, 4
    s_mov_b32 m0, 0
    s_waitcnt lgkmcnt(0)
    v_lshlrev_b32 v72, 15, v72
    v_lshlrev_b32 v73, 15, v73
    v_readlane_b32 s73, v72, 0
    v_readlane_b32 s74, v73, 0
    v_readlane_b32 s79, v72, 1
    v_readlane_b32 s80, v73, 1
    s_mov_b32 s71, s73
    s_cselect_b32 s72, 0x40000000, s74
    buffer_load_dwordx4 v76, s[12:15], s71 offen offset:0 nt lds
    buffer_load_dwordx4 v77, s[12:15], s71 offen offset:1088 nt lds
    buffer_load_dwordx4 v78, s[12:15], s71 offen offset:2176 nt lds
    buffer_load_dwordx4 v79, s[12:15], s71 offen offset:3264 nt lds
    s_mov_b32 m0, 4352
    s_nop 0
    buffer_load_dwordx4 v76, s[12:15], s72 offen offset:0 nt lds
    buffer_load_dwordx4 v77, s[12:15], s72 offen offset:1088 nt lds
    buffer_load_dwordx4 v78, s[12:15], s72 offen offset:2176 nt lds
    buffer_load_dwordx4 v79, s[12:15], s72 offen offset:3264 nt lds
    v_lshlrev_b32 v4, 3, v1
    v_add_u32 v4, 161792, v4
    v_mov_b32 v5, 159232
    s_mov_b32 s73, 159240
    v_writelane_b32 v87, s73, 4
    s_mov_b32 s53, 3
    s_mul_i32 s54, s65, 24
    s_lshr_b32 s54, s54, 8
    s_mul_i32 s55, s65, 44
    s_lshr_b32 s55, s55, 8
    s_mul_i32 s56, s65, 71
    s_lshr_b32 s56, s56, 8
L_next:
    s_sub_u32 s65, s65, 1
    s_cmp_eq_u32 s65, 0
    s_cbranch_scc1 L_lsegend
    s_mov_b32 s34, s71
    s_mov_b32 s64, s72
    s_mov_b32 s71, s79
    s_mov_b32 s72, s80
    s_cmp_lt_u32 s66, s69
    s_cbranch_scc0 L_full_a
L_free_a:
    s_cmp_ge_i32 s53, 6
    s_cbranch_scc1 L_t6_11
    s_cmp_ge_i32 s53, 3
    s_cbranch_scc1 L_t3_5
    s_cmp_ge_i32 s53, 1
    s_cbranch_scc1 L_t1_2
    s_mov_b32 m0, s67
    s_waitcnt vmcnt(8)
    buffer_load_dwordx4 v76, s[12:15], s71 offen offset:0 nt lds
    buffer_load_dwordx4 v77, s[12:15], s71 offen offset:1088 nt lds
    s_waitcnt vmcnt(8)
    buffer_load_dwordx4 v78, s[12:15], s71 offen offset:2176 nt lds
    buffer_load_dwordx4 v79, s[12:15], s71 offen offset:3264 nt lds
    s_add_u32 s70, s70, 1
    s_cmp_eq_u32 s70, s41
    s_cbranch_scc1 L_sw_0
L_swd_0:
    v_readlane_b32 s79, v72, s70
    v_readlane_b32 s80, v73, s70
    s_add_u32 m0, s67, 4352
    s_waitcnt vmcnt(8)
    buffer_load_dwordx4 v76, s[12:15], s72 offen offset:0 nt lds
    buffer_load_dwordx4 v77, s[12:15], s72 offen offset:1088 nt lds
    s_waitcnt vmcnt(8)
    buffer_load_dwordx4 v78, s[12:15], s72 offen offset:2176 nt lds
    buffer_load_dwordx4 v79, s[12:15], s72 offen offset:3264 nt lds
    s_add_u32 m0, s67, 8704
    s_sub_u32 s77, s66, 0
    s_max_i32 s68, s68, s77
    v_mov_b32 v85, s68
    s_waitcnt vmcnt(8)
    ds_write_b32 v14, v85
    buffer_load_dwordx4 v80, s[16:19], s34 offen offset:0 nt lds
    ds_read_b32 v86, v87
    buffer_load_dwordx4 v81, s[16:19], s34 offen offset:1088 nt lds
    s_waitcnt vmcnt(8)
    buffer_load_dwordx4 v82, s[16:19], s34 offen offset:2176 nt lds
    s_waitcnt lgkmcnt(0)
    v_readlane_b32 s73, v86, 0
    v_readlane_b32 s74, v86, 1
    v_readlane_b32 s75, v86, 2
    v_readlane_b32 s76, v86, 3
    s_min_u32 s73, s73, s74
    s_min_u32 s75, s75, s76
    s_min_u32 s69, s73, s75
    s_add_u32 s69, s69, 7
    buffer_load_dwordx4 v83, s[16:19], s34 offen offset:3264 nt lds
    s_add_u32 m0, s67, 13056
    s_waitcnt vmcnt(8)
    buffer_load_dwordx4 v80, s[16:19], s64 offen offset:0 nt lds
    s_add_u32 s67, s67, 17408
    s_cmp_ge_u32 s67, 121856
    s_cselect_b32 s67, 0, s67
    v_readlane_b32 s74, v86, 4
    s_cmp_lt_u32 s66, s56
    s_cselect_b32 s73, 5, 6
    s_cmp_lt_u32 s66, s55
    s_cselect_b32 s73, 4, s73
    s_cmp_lt_u32 s66, s54
    s_cselect_b32 s73, 3, s73
    s_add_u32 s53, s73, s74
    buffer_load_dwordx4 v81, s[16:19], s64 offen offset:1088 nt lds
    s_waitcnt vmcnt(8)
    buffer_load_dwordx4 v82, s[16:19], s64 offen offset:2176 nt lds
    buffer_load_dwordx4 v83, s[16:19], s64 offen offset:3264 nt lds
    s_add_u32 s66, s66, 1
    s_branch L_next
L_t1_2:
    s_cmp_ge_i32 s53, 2
    s_cbranch_scc1 L_t2_2
    s_mov_b32 m0, s67
    s_waitcnt vmcnt(10)
    buffer_load_dwordx4 v76, s[12:15], s71 offen offset:0 nt lds
    buffer_load_dwordx4 v77, s[12:15], s71 offen offset:1088 nt lds
    s_waitcnt vmcnt(10)
    buffer_load_dwordx4 v78, s[12:15], s71 offen offset:2176 nt lds
    buffer_load_dwordx4 v79, s[12:15], s71 offen offset:3264 nt lds
    s_add_u32 s70, s70, 1
    s_cmp_eq_u32 s70, s41
    s_cbranch_scc1 L_sw_1
L_swd_1:
    v_readlane_b32 s79, v72, s70
    v_readlane_b32 s80, v73, s70
    s_add_u32 m0, s67, 4352
    s_waitcnt vmcnt(10)
    buffer_load_dwordx4 v76, s[12:15], s72 offen offset:0 nt lds
    buffer_load_dwordx4 v77, s[12:15], s72 offen offset:1088 nt lds
    s_waitcnt vmcnt(10)
    buffer_load_dwordx4 v78, s[12:15], s72 offen offset:2176 nt lds
    buffer_load_dwordx4 v79, s[12:15], s72 offen offset:3264 nt lds
    s_add_u32 m0, s67, 8704
    s_waitcnt vmcnt(10)
    buffer_load_dwordx4 v80, s[16:19], s34 offen offset:0 nt lds
    ds_read_b32 v86, v87
    buffer_load_dwordx4 v81, s[16:19], s34 offen offset:1088 nt lds
    s_sub_u32 s77, s66, 0
    s_max_i32 s68, s68, s77
    v_mov_b32 v85, s68
    s_waitcnt vmcnt(10)
    ds_write_b32 v14, v85
    buffer_load_dwordx4 v82, s[16:19], s34 offen offset:2176 nt lds
    s_waitcnt lgkmcnt(0)
    v_readlane_b32 s73, v86, 0
    v_readlane_b32 s74, v86, 1
    v_readlane_b32 s75, v86, 2
    v_readlane_b32 s76, v86, 3
    s_min_u32 s73, s73, s74
    s_min_u32 s75, s75, s76
    s_min_u32 s69, s73, s75
    s_add_u32 s69, s69, 7
    buffer_load_dwordx4 v83, s[16:19], s34 offen offset:3264 nt lds
    s_add_u32 m0, s67, 13056
    s_waitcnt vmcnt(10)
    buffer_load_dwordx4 v80, s[16:19], s64 offen offset:0 nt lds
    s_add_u32 s67, s67, 17408
    s_cmp_ge_u32 s67, 121856
    s_cselect_b32 s67, 0, s67
    v_readlane_b32 s74, v86, 4
    s_cmp_lt_u32 s66, s56
    s_cselect_b32 s73, 5, 6
    s_cmp_lt_u32 s66, s55
    s_cselect_b32 s73, 4, s73
    s_cmp_lt_u32 s66, s54
    s_cselect_b32 s73, 3, s73
    s_add_u32 s53, s73, s74
    buffer_load_dwordx4 v81, s[16:19], s64 offen offset:1088 nt lds
    s_waitcnt vmcnt(10)
    buffer_load_dwordx4 v82, s[16:19], s64 offen offset:2176 nt lds
    buffer_load_dwordx4 v83, s[16:19], s64 offen offset:3264 nt lds
    s_add_u32 s66, s66, 1
    s_branch L_next
L_t2_2:
    s_mov_b32 m0, s67
    s_waitcnt vmcnt(12)
    buffer_load_dwordx4 v76, s[12:15], s71 offen offset:0 nt lds
    buffer_load_dwordx4 v77, s[12:15], s71 offen offset:1088 nt lds
    s_waitcnt vmcnt(12)
    buffer_load_dwordx4 v78, s[12:15], s71 offen offset:2176 nt lds
    buffer_load_dwordx4 v79, s[12:15], s71 offen offset:3264 nt lds
    s_add_u32 s70, s70, 1
    s_cmp_eq_u32 s70, s41
    s_cbranch_scc1 L_sw_2
L_swd_2:
    v_readlane_b32 s79, v72, s70
    v_readlane_b32 s80, v73, s70
    s_add_u32 m0, s67, 4352
    s_waitcnt vmcnt(12)
    buffer_load_dwordx4 v76, s[12:15], s72 offen offset:0 nt lds
    buffer_load_dwordx4 v77, s[12:15], s72 offen offset:1088 nt lds
    s_waitcnt vmcnt(12)
    buffer_load_dwordx4 v78, s[12:15], s72 offen offset:2176 nt lds
    buffer_load_dwordx4 v79, s[12:15], s72 offen offset:3264 nt lds
    s_add_u32 m0, s67, 8704
    s_waitcnt vmcnt(12)
    buffer_load_dwordx4 v80, s[16:19], s34 offen offset:0 nt lds
    ds_read_b32 v86, v87
    buffer_load_dwordx4 v81, s[16:19], s34 offen offset:1088 nt lds
    s_waitcnt vmcnt(12)
    buffer_load_dwordx4 v82, s[16:19], s34 offen offset:2176 nt lds
    s_waitcnt lgkmcnt(0)
    v_readlane_b32 s73, v86, 0
    v_readlane_b32 s74, v86, 1
    v_readlane_b32 s75, v86, 2
    v_readlane_b32 s76, v86, 3
    s_min_u32 s73, s73, s74
    s_min_u32 s75, s75, s76
    s_min_u32 s69, s73, s75
    s_add_u32 s69, s69, 7
    buffer_load_dwordx4 v83, s[16:19], s34 offen offset:3264 nt lds
    s_add_u32 m0, s67, 13056
    s_sub_u32 s77, s66, 0
    s_max_i32 s68, s68, s77
    v_mov_b32 v85, s68
    s_waitcnt vmcnt(12)
    ds_write_b32 v14, v85
    buffer_load_dwordx4 v80, s[16:19], s64 offen offset:0 nt lds
    s_add_u32 s67, s67, 17408
    s_cmp_ge_u32 s67, 121856
    s_cselect_b32 s67, 0, s67
    v_readlane_b32 s74, v86, 4
    s_cmp_lt_u32 s66, s56
    s_cselect_b32 s73, 5, 6
    s_cmp_lt_u32 s66, s55
    s_cselect_b32 s73, 4, s73
    s_cmp_lt_u32 s66, s54
    s_cselect_b32 s73, 3, s73
    s_add_u32 s53, s73, s74
    buffer_load_dwordx4 v81, s[16:19], s64 offen offset:1088 nt lds
    s_waitcnt vmcnt(12)
    buffer_load_dwordx4 v82, s[16:19], s64 offen offset:2176 nt lds
    buffer_load_dwordx4 v83, s[16:19], s64 offen offset:3264 nt lds
    s_add_u32 s66, s66, 1
    s_branch L_next
L_t3_5:
    s_cmp_ge_i32 s53, 4
    s_cbranch_scc1 L_t4_5
    s_mov_b32 m0, s67
    s_waitcnt vmcnt(14)
    buffer_load_dwordx4 v76, s[12:15], s71 offen offset:0 nt lds
    buffer_load_dwordx4 v77, s[12:15], s71 offen offset:1088 nt lds
    s_waitcnt vmcnt(14)
    buffer_load_dwordx4 v78, s[12:15], s71 offen offset:2176 nt lds
    buffer_load_dwordx4 v79, s[12:15], s71 offen offset:3264 nt lds
    s_add_u32 s70, s70, 1
    s_cmp_eq_u32 s70, s41
    s_cbranch_scc1 L_sw_3
L_swd_3:
    v_readlane_b32 s79, v72, s70
    v_readlane_b32 s80, v73, s70
    s_add_u32 m0, s67, 4352
    s_waitcnt vmcnt(14)
    buffer_load_dwordx4 v76, s[12:15], s72 offen offset:0 nt lds
    buffer_load_dwordx4 v77, s[12:15], s72 offen offset:1088 nt lds
    s_waitcnt vmcnt(14)
    buffer_load_dwordx4 v78, s[12:15], s72 offen offset:2176 nt lds
    buffer_load_dwordx4 v79, s[12:15], s72 offen offset:3264 nt lds
    s_add_u32 m0, s67, 8704
    s_waitcnt vmcnt(14)
    buffer_load_dwordx4 v80, s[16:19], s34 offen offset:0 nt lds
    ds_read_b32 v86, v87
    buffer_load_dwordx4 v81, s[16:19], s34 offen offset:1088 nt lds
    s_waitcnt vmcnt(14)
    buffer_load_dwordx4 v82, s[16:19], s34 offen offset:2176 nt lds
    s_waitcnt lgkmcnt(0)
    v_readlane_b32 s73, v86, 0
    v_readlane_b32 s74, v86, 1
    v_readlane_b32 s75, v86, 2
    v_readlane_b32 s76, v86, 3
    s_min_u32 s73, s73, s74
    s_min_u32 s75, s75, s76
    s_min_u32 s69, s73, s75
    s_add_u32 s69, s69, 7
    buffer_load_dwordx4 v83, s[16:19], s34 offen offset:3264 nt lds
    s_add_u32 m0, s67, 13056
    s_waitcnt vmcnt(14)
    buffer_load_dwordx4 v80, s[16:19], s64 offen offset:0 nt lds
    s_add_u32 s67, s67, 17408
    s_cmp_ge_u32 s67, 121856
    s_cselect_b32 s67, 0, s67
    v_readlane_b32 s74, v86, 4
    s_cmp_lt_u32 s66, s56
    s_cselect_b32 s73, 5, 6
    s_cmp_lt_u32 s66, s55
    s_cselect_b32 s73, 4, s73
    s_cmp_lt_u32 s66, s54
    s_cselect_b32 s73, 3, s73
    s_add_u32 s53, s73, s74
    buffer_load_dwordx4 v81, s[16:19], s64 offen offset:1088 nt lds
    s_sub_u32 s77, s66, 0
    s_max_i32 s68, s68, s77
    v_mov_b32 v85, s68
    s_waitcnt vmcnt(14)
    ds_write_b32 v14, v85
    buffer_load_dwordx4 v82, s[16:19], s64 offen offset:2176 nt lds
    buffer_load_dwordx4 v83, s[16:19], s64 offen offset:3264 nt lds
    s_add_u32 s66, s66, 1
    s_branch L_next
L_t4_5:
    s_cmp_ge_i32 s53, 5
    s_cbranch_scc1 L_t5_5
    s_mov_b32 m0, s67
    s_sub_u32 s77, s66, 1
    s_max_i32 s68, s68, s77
    v_mov_b32 v85, s68
    s_waitcnt vmcnt(16)
    ds_write_b32 v14, v85
    buffer_load_dwordx4 v76, s[12:15], s71 offen offset:0 nt lds
    buffer_load_dwordx4 v77, s[12:15], s71 offen offset:1088 nt lds
    s_waitcnt vmcnt(16)
    buffer_load_dwordx4 v78, s[12:15], s71 offen offset:2176 nt lds
    buffer_load_dwordx4 v79, s[12:15], s71 offen offset:3264 nt lds
    s_add_u32 s70, s70, 1
    s_cmp_eq_u32 s70, s41
    s_cbranch_scc1 L_sw_4
L_swd_4:
    v_readlane_b32 s79, v72, s70
    v_readlane_b32 s80, v73, s70
    s_add_u32 m0, s67, 4352
    s_waitcnt vmcnt(16)
    buffer_load_dwordx4 v76, s[12:15], s72 offen offset:0 nt lds
    buffer_load_dwordx4 v77, s[12:15], s72 offen offset:1088 nt lds
    s_waitcnt vmcnt(16)
    buffer_load_dwordx4 v78, s[12:15], s72 offen offset:2176 nt lds
    buffer_load_dwordx4 v79, s[12:15], s72 offen offset:3264 nt lds
    s_add_u32 m0, s67, 8704
    s_waitcnt vmcnt(16)
    buffer_load_dwordx4 v80, s[16:19], s34 offen offset:0 nt lds
    ds_read_b32 v86, v87
    buffer_load_dwordx4 v81, s[16:19], s34 offen offset:1088 nt lds
    s_waitcnt vmcnt(16)
    buffer_load_dwordx4 v82, s[16:19], s34 offen offset:2176 nt lds
    s_waitcnt lgkmcnt(0)
    v_readlane_b32 s73, v86, 0
    v_readlane_b32 s74, v86, 1
    v_readlane_b32 s75, v86, 2
    v_readlane_b32 s76, v86, 3
    s_min_u32 s73, s73, s74
    s_min_u32 s75, s75, s76
    s_min_u32 s69, s73, s75
    s_add_u32 s69, s69, 7
    buffer_load_dwordx4 v83, s[16:19], s34 offen offset:3264 nt lds
    s_add_u32 m0, s67, 13056
    s_waitcnt vmcnt(16)
    buffer_load_dwordx4 v80, s[16:19], s64 offen offset:0 nt lds
    s_add_u32 s67, s67, 17408
    s_cmp_ge_u32 s67, 121856
    s_cselect_b32 s67, 0, s67
    v_readlane_b32 s74, v86, 4
    s_cmp_lt_u32 s66, s56
    s_cselect_b32 s73, 5, 6
    s_cmp_lt_u32 s66, s55
    s_cselect_b32 s73, 4, s73
    s_cmp_lt_u32 s66, s54
    s_cselect_b32 s73, 3, s73
    s_add_u32 s53, s73, s74
    buffer_load_dwordx4 v81, s[16:19], s64 offen offset:1088 nt lds
    s_waitcnt vmcnt(16)
    buffer_load_dwordx4 v82, s[16:19], s64 offen offset:2176 nt lds
    buffer_load_dwordx4 v83, s[16:19], s64 offen offset:3264 nt lds
    s_add_u32 s66, s66, 1
    s_branch L_next
L_t5_5:
    s_mov_b32 m0, s67
    s_waitcnt vmcnt(18)
    buffer_load_dwordx4 v76, s[12:15], s71 offen offset:0 nt lds
    buffer_load_dwordx4 v77, s[12:15], s71 offen offset:1088 nt lds
    s_sub_u32 s77, s66, 1
    s_max_i32 s68, s68, s77
    v_mov_b32 v85, s68
    s_waitcnt vmcnt(18)
    ds_write_b32 v14, v85
    buffer_load_dwordx4 v78, s[12:15], s71 offen offset:2176 nt lds
    buffer_load_dwordx4 v79, s[12:15], s71 offen offset:3264 nt lds
    s_add_u32 s70, s70, 1
    s_cmp_eq_u32 s70, s41
    s_cbranch_scc1 L_sw_5
L_swd_5:
    v_readlane_b32 s79, v72, s70
    v_readlane_b32 s80, v73, s70
    s_add_u32 m0, s67, 4352
    s_waitcnt vmcnt(18)
    buffer_load_dwordx4 v76, s[12:15], s72 offen offset:0 nt lds
    buffer_load_dwordx4 v77, s[12:15], s72 offen offset:1088 nt lds
    s_waitcnt vmcnt(18)
    buffer_load_dwordx4 v78, s[12:15], s72 offen offset:2176 nt lds
    buffer_load_dwordx4 v79, s[12:15], s72 offen offset:3264 nt lds
    s_add_u32 m0, s67, 8704
    s_waitcnt vmcnt(18)
    buffer_load_dwordx4 v80, s[16:19], s34 offen offset:0 nt lds
    ds_read_b32 v86, v87
    buffer_load_dwordx4 v81, s[16:19], s34 offen offset:1088 nt lds
    s_waitcnt vmcnt(18)
    buffer_load_dwordx4 v82, s[16:19], s34 offen offset:2176 nt lds
    s_waitcnt lgkmcnt(0)
    v_readlane_b32 s73, v86, 0
    v_readlane_b32 s74, v86, 1
    v_readlane_b32 s75, v86, 2
    v_readlane_b32 s76, v86, 3
    s_min_u32 s73, s73, s74
    s_min_u32 s75, s75, s76
    s_min_u32 s69, s73, s75
    s_add_u32 s69, s69, 7
    buffer_load_dwordx4 v83, s[16:19], s34 offen offset:3264 nt lds
    s_add_u32 m0, s67, 13056
    s_waitcnt vmcnt(18)
    buffer_load_dwordx4 v80, s[16:19], s64 offen offset:0 nt lds
    s_add_u32 s67, s67, 17408
    s_cmp_ge_u32 s67, 121856
    s_cselect_b32 s67, 0, s67
    v_readlane_b32 s74, v86, 4
    s_cmp_lt_u32 s66, s56
    s_cselect_b32 s73, 5, 6
    s_cmp_lt_u32 s66, s55
    s_cselect_b32 s73, 4, s73
    s_cmp_lt_u32 s66, s54
    s_cselect_b32 s73, 3, s73
    s_add_u32 s53, s73, s74
    buffer_load_dwordx4 v81, s[16:19], s64 offen offset:1088 nt lds
    s_waitcnt vmcnt(18)
    buffer_load_dwordx4 v82, s[16:19], s64 offen offset:2176 nt lds
    buffer_load_dwordx4 v83, s[16:19], s64 offen offset:3264 nt lds
    s_add_u32 s66, s66, 1
    s_branch L_next
L_t6_11:
    s_cmp_ge_i32 s53, 9
    s_cbranch_scc1 L_t9_11
    s_cmp_ge_i32 s53, 7
    s_cbranch_scc1 L_t7_8
    s_mov_b32 m0, s67
    s_waitcnt vmcnt(20)
    buffer_load_dwordx4 v76, s[12:15], s71 offen offset:0 nt lds
    buffer_load_dwordx4 v77, s[12:15], s71 offen offset:1088 nt lds
    s_waitcnt vmcnt(20)
    buffer_load_dwordx4 v78, s[12:15], s71 offen offset:2176 nt lds
    buffer_load_dwordx4 v79, s[12:15], s71 offen offset:3264 nt lds
    s_add_u32 s70, s70, 1
    s_cmp_eq_u32 s70, s41
    s_cbranch_scc1 L_sw_6
L_swd_6:
    v_readlane_b32 s79, v72, s70
    v_readlane_b32 s80, v73, s70
    s_add_u32 m0, s67, 4352
    s_sub_u32 s77, s66, 1
    s_max_i32 s68, s68, s77
    v_mov_b32 v85, s68
    s_waitcnt vmcnt(20)
    ds_write_b32 v14, v85
    buffer_load_dwordx4 v76, s[12:15], s72 offen offset:0 nt lds
    buffer_load_dwordx4 v77, s[12:15], s72 offen offset:1088 nt lds
    s_waitcnt vmcnt(20)
    buffer_load_dwordx4 v78, s[12:15], s72 offen offset:2176 nt lds
    buffer_load_dwordx4 v79, s[12:15], s72 offen offset:3264 nt lds
    s_add_u32 m0, s67, 8704
    s_waitcnt vmcnt(20)
    buffer_load_dwordx4 v80, s[16:19], s34 offen offset:0 nt lds
    ds_read_b32 v86, v87
    buffer_load_dwordx4 v81, s[16:19], s34 offen offset:1088 nt lds
    s_waitcnt vmcnt(20)
    buffer_load_dwordx4 v82, s[16:19], s34 offen offset:2176 nt lds
    s_waitcnt lgkmcnt(0)
    v_readlane_b32 s73, v86, 0
    v_readlane_b32 s74, v86, 1
    v_readlane_b32 s75, v86, 2
    v_readlane_b32 s76, v86, 3
    s_min_u32 s73, s73, s74
    s_min_u32 s75, s75, s76
    s_min_u32 s69, s73, s75
    s_add_u32 s69, s69, 7
    buffer_load_dwordx4 v83, s[16:19], s34 offen offset:3264 nt lds
    s_add_u32 m0, s67, 13056
    s_waitcnt vmcnt(20)
    buffer_load_dwordx4 v80, s[16:19], s64 offen offset:0 nt lds
    s_add_u32 s67, s67, 17408
    s_cmp_ge_u32 s67, 121856
    s_cselect_b32 s67, 0, s67
    v_readlane_b32 s74, v86, 4
    s_cmp_lt_u32 s66, s56
    s_cselect_b32 s73, 5, 6
    s_cmp_lt_u32 s66, s55
    s_cselect_b32 s73, 4, s73
    s_cmp_lt_u32 s66, s54
    s_cselect_b32 s73, 3, s73
    s_add_u32 s53, s73, s74
    buffer_load_dwordx4 v81, s[16:19], s64 offen offset:1088 nt lds
    s_waitcnt vmcnt(20)
    buffer_load_dwordx4 v82, s[16:19], s64 offen offset:2176 nt lds
    buffer_load_dwordx4 v83, s[16:19], s64 offen offset:3264 nt lds
    s_add_u32 s66, s66, 1
    s_branch L_next
L_t7_8:
    s_cmp_ge_i32 s53, 8
    s_cbranch_scc1 L_t8_8
    s_mov_b32 m0, s67
    s_waitcnt vmcnt(22)
    buffer_load_dwordx4 v76, s[12:15], s71 offen offset:0 nt lds
    buffer_load_dwordx4 v77, s[12:15], s71 offen offset:1088 nt lds
    s_waitcnt vmcnt(22)
    buffer_load_dwordx4 v78, s[12:15], s71 offen offset:2176 nt lds
    buffer_load_dwordx4 v79, s[12:15], s71 offen offset:3264 nt lds
    s_add_u32 s70, s70, 1
    s_cmp_eq_u32 s70, s41
    s_cbranch_scc1 L_sw_7
L_swd_7:
    v_readlane_b32 s79, v72, s70
    v_readlane_b32 s80, v73, s70
    s_add_u32 m0, s67, 4352
    s_waitcnt vmcnt(22)
    buffer_load_dwordx4 v76, s[12:15], s72 offen offset:0 nt lds
    buffer_load_dwordx4 v77, s[12:15], s72 offen offset:1088 nt lds
    s_sub_u32 s77, s66, 1
    s_max_i32 s68, s68, s77
    v_mov_b32 v85, s68
    s_waitcnt vmcnt(22)
    ds_write_b32 v14, v85
    buffer_load_dwordx4 v78, s[12:15], s72 offen offset:2176 nt lds
    buffer_load_dwordx4 v79, s[12:15], s72 offen offset:3264 nt lds
    s_add_u32 m0, s67, 8704
    s_waitcnt vmcnt(22)
    buffer_load_dwordx4 v80, s[16:19], s34 offen offset:0 nt lds
    ds_read_b32 v86, v87
    buffer_load_dwordx4 v81, s[16:19], s34 offen offset:1088 nt lds
    s_waitcnt vmcnt(22)
    buffer_load_dwordx4 v82, s[16:19], s34 offen offset:2176 nt lds
    s_waitcnt lgkmcnt(0)
    v_readlane_b32 s73, v86, 0
    v_readlane_b32 s74, v86, 1
    v_readlane_b32 s75, v86, 2
    v_readlane_b32 s76, v86, 3
    s_min_u32 s73, s73, s74
    s_min_u32 s75, s75, s76
    s_min_u32 s69, s73, s75
    s_add_u32 s69, s69, 7
    buffer_load_dwordx4 v83, s[16:19], s34 offen offset:3264 nt lds
    s_add_u32 m0, s67, 13056
    s_waitcnt vmcnt(22)
    buffer_load_dwordx4 v80, s[16:19], s64 offen offset:0 nt lds
    s_add_u32 s67, s67, 17408
    s_cmp_ge_u32 s67, 121856
    s_cselect_b32 s67, 0, s67
    v_readlane_b32 s74, v86, 4
    s_cmp_lt_u32 s66, s56
    s_cselect_b32 s73, 5, 6
    s_cmp_lt_u32 s66, s55
    s_cselect_b32 s73, 4, s73
    s_cmp_lt_u32 s66, s54
    s_cselect_b32 s73, 3, s73
    s_add_u32 s53, s73, s74
    buffer_load_dwordx4 v81, s[16:19], s64 offen offset:1088 nt lds
    s_waitcnt vmcnt(22)
    buffer_load_dwordx4 v82, s[16:19], s64 offen offset:2176 nt lds
    buffer_load_dwordx4 v83, s[16:19], s64 offen offset:3264 nt lds
    s_add_u32 s66, s66, 1
    s_branch L_next
L_t8_8:
    s_mov_b32 m0, s67
    s_waitcnt vmcnt(24)
    buffer_load_dwordx4 v76, s[12:15], s71 offen offset:0 nt lds
    buffer_load_dwordx4 v77, s[12:15], s71 offen offset:1088 nt lds
    s_waitcnt vmcnt(24)
    buffer_load_dwordx4 v78, s[12:15], s71 offen offset:2176 nt lds
    buffer_load_dwordx4 v79, s[12:15], s71 offen offset:3264 nt lds
    s_add_u32 s70, s70, 1
    s_cmp_eq_u32 s70, s41
    s_cbranch_scc1 L_sw_8
L_swd_8:
    v_readlane_b32 s79, v72, s70
    v_readlane_b32 s80, v73, s70
    s_add_u32 m0, s67, 4352
    s_waitcnt vmcnt(24)
    buffer_load_dwordx4 v76, s[12:15], s72 offen offset:0 nt lds
    buffer_load_dwordx4 v77, s[12:15], s72 offen offset:1088 nt lds
    s_waitcnt vmcnt(24)
    buffer_load_dwordx4 v78, s[12:15], s72 offen offset:2176 nt lds
    buffer_load_dwordx4 v79, s[12:15], s72 offen offset:3264 nt lds
    s_add_u32 m0, s67, 8704
    s_sub_u32 s77, s66, 1
    s_max_i32 s68, s68, s77
    v_mov_b32 v85, s68
    s_waitcnt vmcnt(24)
    ds_write_b32 v14, v85
    buffer_load_dwordx4 v80, s[16:19], s34 offen offset:0 nt lds
    ds_read_b32 v86, v87
    buffer_load_dwordx4 v81, s[16:19], s34 offen offset:1088 nt lds
    s_waitcnt vmcnt(24)
    buffer_load_dwordx4 v82, s[16:19], s34 offen offset:2176 nt lds
    s_waitcnt lgkmcnt(0)
    v_readlane_b32 s73, v86, 0
    v_readlane_b32 s74, v86, 1
    v_readlane_b32 s75, v86, 2
    v_readlane_b32 s76, v86, 3
    s_min_u32 s73, s73, s74
    s_min_u32 s75, s75, s76
    s_min_u32 s69, s73, s75
    s_add_u32 s69, s69, 7
    buffer_load_dwordx4 v83, s[16:19], s34 offen offset:3264 nt lds
    s_add_u32 m0, s67, 13056
    s_waitcnt vmcnt(24)
    buffer_load_dwordx4 v80, s[16:19], s64 offen offset:0 nt lds
    s_add_u32 s67, s67, 17408
    s_cmp_ge_u32 s67, 121856
    s_cselect_b32 s67, 0, s67
    v_readlane_b32 s74, v86, 4
    s_cmp_lt_u32 s66, s56
    s_cselect_b32 s73, 5, 6
    s_cmp_lt_u32 s66, s55
    s_cselect_b32 s73, 4, s73
    s_cmp_lt_u32 s66, s54
    s_cselect_b32 s73, 3, s73
    s_add_u32 s53, s73, s74
    buffer_load_dwordx4 v81, s[16:19], s64 offen offset:1088 nt lds
    s_waitcnt vmcnt(24)
    buffer_load_dwordx4 v82, s[16:19], s64 offen offset:2176 nt lds
    buffer_load_dwordx4 v83, s[16:19], s64 offen offset:3264 nt lds
    s_add_u32 s66, s66, 1
    s_branch L_next
L_t9_11:
    s_cmp_ge_i32 s53, 10
    s_cbranch_scc1 L_t10_11
    s_mov_b32 m0, s67
    s_waitcnt vmcnt(26)
    buffer_load_dwordx4 v76, s[12:15], s71 offen offset:0 nt lds
    buffer_load_dwordx4 v77, s[12:15], s71 offen offset:1088 nt lds
    s_waitcnt vmcnt(26)
    buffer_load_dwordx4 v78, s[12:15], s71 offen offset:2176 nt lds
    buffer_load_dwordx4 v79, s[12:15], s71 offen offset:3264 nt lds
    s_add_u32 s70, s70, 1
    s_cmp_eq_u32 s70, s41
    s_cbranch_scc1 L_sw_9
L_swd_9:
    v_readlane_b32 s79, v72, s70
    v_readlane_b32 s80, v73, s70
    s_add_u32 m0, s67, 4352
    s_waitcnt vmcnt(26)
    buffer_load_dwordx4 v76, s[12:15], s72 offen offset:0 nt lds
    buffer_load_dwordx4 v77, s[12:15], s72 offen offset:1088 nt lds
    s_waitcnt vmcnt(26)
    buffer_load_dwordx4 v78, s[12:15], s72 offen offset:2176 nt lds
    buffer_load_dwordx4 v79, s[12:15], s72 offen offset:3264 nt lds
    s_add_u32 m0, s67, 8704
    s_waitcnt vmcnt(26)
    buffer_load_dwordx4 v80, s[16:19], s34 offen offset:0 nt lds
    ds_read_b32 v86, v87
    buffer_load_dwordx4 v81, s[16:19], s34 offen offset:1088 nt lds
    s_sub_u32 s77, s66, 1
    s_max_i32 s68, s68, s77
    v_mov_b32 v85, s68
    s_waitcnt vmcnt(26)
    ds_write_b32 v14, v85
    buffer_load_dwordx4 v82, s[16:19], s34 offen offset:2176 nt lds
    s_waitcnt lgkmcnt(0)
    v_readlane_b32 s73, v86, 0
    v_readlane_b32 s74, v86, 1
    v_readlane_b32 s75, v86, 2
    v_readlane_b32 s76, v86, 3
    s_min_u32 s73, s73, s74
    s_min_u32 s75, s75, s76
    s_min_u32 s69, s73, s75
    s_add_u32 s69, s69, 7
    buffer_load_dwordx4 v83, s[16:19], s34 offen offset:3264 nt lds
    s_add_u32 m0, s67, 13056
    s_waitcnt vmcnt(26)
    buffer_load_dwordx4 v80, s[16:19], s64 offen offset:0 nt lds
    s_add_u32 s67, s67, 17408
    s_cmp_ge_u32 s67, 121856
    s_cselect_b32 s67, 0, s67
    v_readlane_b32 s74, v86, 4
    s_cmp_lt_u32 s66, s56
    s_cselect_b32 s73, 5, 6
    s_cmp_lt_u32 s66, s55
    s_cselect_b32 s73, 4, s73
    s_cmp_lt_u32 s66, s54
    s_cselect_b32 s73, 3, s73
    s_add_u32 s53, s73, s74
    buffer_load_dwordx4 v81, s[16:19], s64 offen offset:1088 nt lds
    s_waitcnt vmcnt(26)
    buffer_load_dwordx4 v82, s[16:19], s64 offen offset:2176 nt lds
    buffer_load_dwordx4 v83, s[16:19], s64 offen offset:3264 nt lds
    s_add_u32 s66, s66, 1
    s_branch L_next
L_t10_11:
    s_cmp_ge_i32 s53, 11
    s_cbranch_scc1 L_t11_11
    s_mov_b32 m0, s67
    s_waitcnt vmcnt(28)
    buffer_load_dwordx4 v76, s[12:15], s71 offen offset:0 nt lds
    buffer_load_dwordx4 v77, s[12:15], s71 offen offset:1088 nt lds
    s_waitcnt vmcnt(28)
    buffer_load_dwordx4 v78, s[12:15], s71 offen offset:2176 nt lds
    buffer_load_dwordx4 v79, s[12:15], s71 offen offset:3264 nt lds
    s_add_u32 s70, s70, 1
    s_cmp_eq_u32 s70, s41
    s_cbranch_scc1 L_sw_10
L_swd_10:
    v_readlane_b32 s79, v72, s70
    v_readlane_b32 s80, v73, s70
    s_add_u32 m0, s67, 4352
    s_waitcnt vmcnt(28)
    buffer_load_dwordx4 v76, s[12:15], s72 offen offset:0 nt lds
    buffer_load_dwordx4 v77, s[12:15], s72 offen offset:1088 nt lds
    s_waitcnt vmcnt(28)
    buffer_load_dwordx4 v78, s[12:15], s72 offen offset:2176 nt lds
    buffer_load_dwordx4 v79, s[12:15], s72 offen offset:3264 nt lds
    s_add_u32 m0, s67, 8704
    s_waitcnt vmcnt(28)
    buffer_load_dwordx4 v80, s[16:19], s34 offen offset:0 nt lds
    ds_read_b32 v86, v87
    buffer_load_dwordx4 v81, s[16:19], s34 offen offset:1088 nt lds
    s_waitcnt vmcnt(28)
    buffer_load_dwordx4 v82, s[16:19], s34 offen offset:2176 nt lds
    s_waitcnt lgkmcnt(0)
    v_readlane_b32 s73, v86, 0
    v_readlane_b32 s74, v86, 1
    v_readlane_b32 s75, v86, 2
    v_readlane_b32 s76, v86, 3
    s_min_u32 s73, s73, s74
    s_min_u32 s75, s75, s76
    s_min_u32 s69, s73, s75
    s_add_u32 s69, s69, 7
    buffer_load_dwordx4 v83, s[16:19], s34 offen offset:3264 nt lds
    s_add_u32 m0, s67, 13056
    s_sub_u32 s77, s66, 1
    s_max_i32 s68, s68, s77
    v_mov_b32 v85, s68
    s_waitcnt vmcnt(28)
    ds_write_b32 v14, v85
    buffer_load_dwordx4 v80, s[16:19], s64 offen offset:0 nt lds
    s_add_u32 s67, s67, 17408
    s_cmp_ge_u32 s67, 121856
    s_cselect_b32 s67, 0, s67
    v_readlane_b32 s74, v86, 4
    s_cmp_lt_u32 s66, s56
    s_cselect_b32 s73, 5, 6
    s_cmp_lt_u32 s66, s55
    s_cselect_b32 s73, 4, s73
    s_cmp_lt_u32 s66, s54
    s_cselect_b32 s73, 3, s73
    s_add_u32 s53, s73, s74
    buffer_load_dwordx4 v81, s[16:19], s64 offen offset:1088 nt lds
    s_waitcnt vmcnt(28)
    buffer_load_dwordx4 v82, s[16:19], s64 offen offset:2176 nt lds
    buffer_load_dwordx4 v83, s[16:19], s64 offen offset:3264 nt lds
    s_add_u32 s66, s66, 1
    s_branch L_next
L_t11_11:
    s_mov_b32 m0, s67
    s_waitcnt vmcnt(30)
    buffer_load_dwordx4 v76, s[12:15], s71 offen offset:0 nt lds
    buffer_load_dwordx4 v77, s[12:15], s71 offen offset:1088 nt lds
    s_waitcnt vmcnt(30)
    buffer_load_dwordx4 v78, s[12:15], s71 offen offset:2176 nt lds
    buffer_load_dwordx4 v79, s[12:15], s71 offen offset:3264 nt lds
    s_add_u32 s70, s70, 1
    s_cmp_eq_u32 s70, s41
    s_cbranch_scc1 L_sw_11
L_swd_11:
    v_readlane_b32 s79, v72, s70
    v_readlane_b32 s80, v73, s70
    s_add_u32 m0, s67, 4352
    s_waitcnt vmcnt(30)
    buffer_load_dwordx4 v76, s[12:15], s72 offen offset:0 nt lds
    buffer_load_dwordx4 v77, s[12:15], s72 offen offset:1088 nt lds
    s_waitcnt vmcnt(30)
    buffer_load_dwordx4 v78, s[12:15], s72 offen offset:2176 nt lds
    buffer_load_dwordx4 v79, s[12:15], s72 offen offset:3264 nt lds
    s_add_u32 m0, s67, 8704
    s_waitcnt vmcnt(30)
    buffer_load_dwordx4 v80, s[16:19], s34 offen offset:0 nt lds
    ds_read_b32 v86, v87
    buffer_load_dwordx4 v81, s[16:19], s34 offen offset:1088 nt lds
    s_waitcnt vmcnt(30)
    buffer_load_dwordx4 v82, s[16:19], s34 offen offset:2176 nt lds
    s_waitcnt lgkmcnt(0)
    v_readlane_b32 s73, v86, 0
    v_readlane_b32 s74, v86, 1
    v_readlane_b32 s75, v86, 2
    v_readlane_b32 s76, v86, 3
    s_min_u32 s73, s73, s74
    s_min_u32 s75, s75, s76
    s_min_u32 s69, s73, s75
    s_add_u32 s69, s69, 7
    buffer_load_dwordx4 v83, s[16:19], s34 offen offset:3264 nt lds
    s_add_u32 m0, s67, 13056
    s_waitcnt vmcnt(30)
    buffer_load_dwordx4 v80, s[16:19], s64 offen offset:0 nt lds
    s_add_u32 s67, s67, 17408
    s_cmp_ge_u32 s67, 121856
    s_cselect_b32 s67, 0, s67
    v_readlane_b32 s74, v86, 4
    s_cmp_lt_u32 s66, s56
    s_cselect_b32 s73, 5, 6
    s_cmp_lt_u32 s66, s55
    s_cselect_b32 s73, 4, s73
    s_cmp_lt_u32 s66, s54
    s_cselect_b32 s73, 3, s73
    s_add_u32 s53, s73, s74
    buffer_load_dwordx4 v81, s[16:19], s64 offen offset:1088 nt lds
    s_sub_u32 s77, s66, 1
    s_max_i32 s68, s68, s77
    v_mov_b32 v85, s68
    s_waitcnt vmcnt(30)
    ds_write_b32 v14, v85
    buffer_load_dwordx4 v82, s[16:19], s64 offen offset:2176 nt lds
    buffer_load_dwordx4 v83, s[16:19], s64 offen offset:3264 nt lds
    s_add_u32 s66, s66, 1
    s_branch L_next
L_lsegend:
    ds_read_b32 v84, v5
    s_cmp_lt_u32 s66, s69
    s_cbranch_scc0 L_full_e
L_free_e:
    s_add_u32 m0, s67, 8704
    s_nop 0
    buffer_load_dwordx4 v80, s[16:19], s71 offen offset:0 nt lds
    buffer_load_dwordx4 v81, s[16:19], s71 offen offset:1088 nt lds
    buffer_load_dwordx4 v82, s[16:19], s71 offen offset:2176 nt lds
    buffer_load_dwordx4 v83, s[16:19], s71 offen offset:3264 nt lds
    s_add_u32 m0, s67, 13056
    s_nop 0
    buffer_load_dwordx4 v80, s[16:19], s72 offen offset:0 nt lds
    buffer_load_dwordx4 v81, s[16:19], s72 offen offset:1088 nt lds
    s_sub_u32 s77, s66, 1
    s_max_i32 s68, s68, s77
    v_mov_b32 v85, s68
    s_waitcnt vmcnt(22)
    ds_write_b32 v14, v85
    buffer_load_dwordx4 v82, s[16:19], s72 offen offset:2176 nt lds
    buffer_load_dwordx4 v83, s[16:19], s72 offen offset:3264 nt lds
    s_bitcmp1_b32 s33, 0
    s_cselect_b32 s48, s36, s35
    s_lshl_b32 s48, s48, 3
    s_add_u32 s48, s48, s32
    s_lshl_b32 s48, s48, 15
    s_add_u32 s48, s48, s47
    v_lshrrev_b32 v93, 5, v1
    v_lshlrev_b32 v93, 12, v93
    v_lshl_add_u32 v93, v1, 7, v93
    v_lshlrev_b32 v95, 7, v1
    s_xor_b32 s73, s33, 2
    s_lshr_b32 s74, s33, 1
    s_add_u32 s74, s74, 4
    s_mul_i32 s50, s44, 6
    s_add_u32 s50, s50, s73
    s_mul_i32 s50, s50, 17408
    s_mul_i32 s49, s44, 6
    s_add_u32 s49, s49, s74
    s_mul_i32 s49, s49, 17408
    s_cmp_eq_u32 s42, 0
    s_cselect_b32 s49, 0x40000000, s49
    s_cselect_b32 s51, s50, s49
    v_and_b32 v94, 4, v1
    v_cmp_eq_u32 vcc, 0, v94
    v_mov_b32 v94, s50
    v_mov_b32 v96, s51
    v_and_b32 v97, 3, v1
    v_cndmask_b32 v94, v96, v94, vcc
    v_lshl_add_u32 v94, v97, 7, v94
    s_sub_u32 s77, s66, 0
    s_max_i32 s68, s68, s77
    v_mov_b32 v85, s68
    s_waitcnt vmcnt(8)
    ds_write_b32 v14, v85
    s_waitcnt lgkmcnt(0)
    v_readfirstlane_b32 s73, v84
    s_nop 0
    s_cmp_eq_u32 s73, 1
    s_cselect_b32 s48, s48, 0x40000000
    s_cselect_b32 s49, s49, 0x40000000
    s_cselect_b32 s50, 16384, 0x40000000
    s_mov_b32 m0, 162304
    s_add_u32 s51, s48, 16384
    s_add_u32 s52, s49, 8192
    buffer_load_dword v94, s[20:23], s50 offen  lds
    buffer_load_dword v93, s[24:27], s48 offen  lds
    buffer_load_dword v93, s[24:27], s51 offen  lds
    buffer_load_dword v95, s[20:23], s49 offen  lds
    buffer_load_dword v95, s[20:23], s52 offen  lds
    s_add_u32 s73, s66, 1
    v_mov_b32 v85, s73
    s_waitcnt vmcnt(5)
    ds_write_b32 v14, v85
L_ldone:
    s_endpgm
L_sw_0:
    s_sub_u32 s46, s46, 1
    s_cbranch_scc1 L_end
    ds_read_b32 v86, v5 offset:4
    ds_read_b64 v[72:73], v4
    s_waitcnt lgkmcnt(0)
    v_readfirstlane_b32 s73, v86
    s_nop 0
    s_cmp_eq_u32 s73, 0
    s_cbranch_scc1 L_sw_0
    s_mov_b32 s70, 0
    s_mov_b32 s41, -1
    s_branch L_swd_0
L_sw_1:
    s_sub_u32 s46, s46, 1
    s_cbranch_scc1 L_end
    ds_read_b32 v86, v5 offset:4
    ds_read_b64 v[72:73], v4
    s_waitcnt lgkmcnt(0)
    v_readfirstlane_b32 s73, v86
    s_nop 0
    s_cmp_eq_u32 s73, 0
    s_cbranch_scc1 L_sw_1
    s_mov_b32 s70, 0
    s_mov_b32 s41, -1
    s_branch L_swd_1
L_sw_2:
    s_sub_u32 s46, s46, 1
    s_cbranch_scc1 L_end
    ds_read_b32 v86, v5 offset:4
    ds_read_b64 v[72:73], v4
    s_waitcnt lgkmcnt(0)
    v_readfirstlane_b32 s73, v86
    s_nop 0
    s_cmp_eq_u32 s73, 0
    s_cbranch_scc1 L_sw_2
    s_mov_b32 s70, 0
    s_mov_b32 s41, -1
    s_branch L_swd_2
L_sw_3:
    s_sub_u32 s46, s46, 1
    s_cbranch_scc1 L_end
    ds_read_b32 v86, v5 offset:4
    ds_read_b64 v[72:73], v4
    s_waitcnt lgkmcnt(0)
    v_readfirstlane_b32 s73, v86
    s_nop 0
    s_cmp_eq_u32 s73, 0
    s_cbranch_scc1 L_sw_3
    s_mov_b32 s70, 0
    s_mov_b32 s41, -1
    s_branch L_swd_3
L_sw_4:
    s_sub_u32 s46, s46, 1
    s_cbranch_scc1 L_end
    ds_read_b32 v86, v5 offset:4
    ds_read_b64 v[72:73], v4
    s_waitcnt lgkmcnt(0)
    v_readfirstlane_b32 s73, v86
    s_nop 0
    s_cmp_eq_u32 s73, 0
    s_cbranch_scc1 L_sw_4
    s_mov_b32 s70, 0
    s_mov_b32 s41, -1
    s_branch L_swd_4
L_sw_5:
    s_sub_u32 s46, s46, 1
    s_cbranch_scc1 L_end
    ds_read_b32 v86, v5 offset:4
    ds_read_b64 v[72:73], v4
    s_waitcnt lgkmcnt(0)
    v_readfirstlane_b32 s73, v86
    s_nop 0
    s_cmp_eq_u32 s73, 0
    s_cbranch_scc1 L_sw_5
    s_mov_b32 s70, 0
    s_mov_b32 s41, -1
    s_branch L_swd_5
L_sw_6:
    s_sub_u32 s46, s46, 1
    s_cbranch_scc1 L_end
    ds_read_b32 v86, v5 offset:4
    ds_read_b64 v[72:73], v4
    s_waitcnt lgkmcnt(0)
    v_readfirstlane_b32 s73, v86
    s_nop 0
    s_cmp_eq_u32 s73, 0
    s_cbranch_scc1 L_sw_6
    s_mov_b32 s70, 0
    s_mov_b32 s41, -1
    s_branch L_swd_6
L_sw_7:
    s_sub_u32 s46, s46, 1
    s_cbranch_scc1 L_end
    ds_read_b32 v86, v5 offset:4
    ds_read_b64 v[72:73], v4
    s_waitcnt lgkmcnt(0)
    v_readfirstlane_b32 s73, v86
    s_nop 0
    s_cmp_eq_u32 s73, 0
    s_cbranch_scc1 L_sw_7
    s_mov_b32 s70, 0
    s_mov_b32 s41, -1
    s_branch L_swd_7
L_sw_8:
    s_sub_u32 s46, s46, 1
    s_cbranch_scc1 L_end
    ds_read_b32 v86, v5 offset:4
    ds_read_b64 v[72:73], v4
    s_waitcnt lgkmcnt(0)
    v_readfirstlane_b32 s73, v86
    s_nop 0
    s_cmp_eq_u32 s73, 0
    s_cbranch_scc1 L_sw_8
    s_mov_b32 s70, 0
    s_mov_b32 s41, -1
    s_branch L_swd_8
L_sw_9:
    s_sub_u32 s46, s46, 1
    s_cbranch_scc1 L_end
    ds_read_b32 v86, v5 offset:4
    ds_read_b64 v[72:73], v4
    s_waitcnt lgkmcnt(0)
    v_readfirstlane_b32 s73, v86
    s_nop 0
    s_cmp_eq_u32 s73, 0
    s_cbranch_scc1 L_sw_9
    s_mov_b32 s70, 0
    s_mov_b32 s41, -1
    s_branch L_swd_9
L_sw_10:
    s_sub_u32 s46, s46, 1
    s_cbranch_scc1 L_end
    ds_read_b32 v86, v5 offset:4
    ds_read_b64 v[72:73], v4
    s_waitcnt lgkmcnt(0)
    v_readfirstlane_b32 s73, v86
    s_nop 0
    s_cmp_eq_u32 s73, 0
    s_cbranch_scc1 L_sw_10
    s_mov_b32 s70, 0
    s_mov_b32 s41, -1
    s_branch L_swd_10
L_sw_11:
    s_sub_u32 s46, s46, 1
    s_cbranch_scc1 L_end
    ds_read_b32 v86, v5 offset:4
    ds_read_b64 v[72:73], v4
    s_waitcnt lgkmcnt(0)
    v_readfirstlane_b32 s73, v86
    s_nop 0
    s_cmp_eq_u32 s73, 0
    s_cbranch_scc1 L_sw_11
    s_mov_b32 s70, 0
    s_mov_b32 s41, -1
    s_branch L_swd_11
L_full_a:
    s_sub_u32 s46, s46, 1
    s_cbranch_scc1 L_end
    ds_read_b32 v86, v87
    s_waitcnt lgkmcnt(0)
    v_readlane_b32 s73, v86, 0
    v_readlane_b32 s74, v86, 1
    v_readlane_b32 s75, v86, 2
    v_readlane_b32 s76, v86, 3
    s_min_u32 s73, s73, s74
    s_min_u32 s75, s75, s76
    s_min_u32 s69, s73, s75
    s_add_u32 s69, s69, 7
    s_cmp_lt_u32 s66, s69
    s_cbranch_scc0 L_full_a
    s_branch L_free_a
L_full_e:
    s_sub_u32 s46, s46, 1
    s_cbranch_scc1 L_end
    ds_read_b32 v86, v87
    s_waitcnt lgkmcnt(0)
    v_readlane_b32 s73, v86, 0
    v_readlane_b32 s74, v86, 1
    v_readlane_b32 s75, v86, 2
    v_readlane_b32 s76, v86, 3
    s_min_u32 s73, s73, s74
    s_min_u32 s75, s75, s76
    s_min_u32 s69, s73, s75
    s_add_u32 s69, s69, 7
    s_cmp_lt_u32 s66, s69
    s_cbranch_scc0 L_full_e
    s_branch L_free_e
L_pacer:
    s_add_u32 s65, s37, s38
    s_lshr_b32 s55, s2, 3
    s_sub_u32 s73, s65, 48
    s_mul_i32 s73, s73, 45
    s_add_u32 s73, s73, 95
    s_ashr_i32 s73, s73, 8
    s_min_i32 s73, s73, 5
    s_max_i32 s73, s73, -6
    v_mov_b32 v101, s73
    v_mov_b32 v5, 159240
    ds_write_b32 v5, v101
    v_mov_b32 v105, v101
    s_and_b32 s73, s2, 7
    s_lshl_b32 s73, s73, 7
    s_add_u32 s56, s73, 6684672
    v_and_b32 v98, 31, v1
    v_lshlrev_b32 v98, 2, v98
    s_lshl_b64 s[58:59], 1, s55
    buffer_load_dword v99, v98, s[20:23], s56 offen sc1
    s_and_b32 s57, s55, 1
    s_add_u32 s57, s57, 3
    s_waitcnt vmcnt(0)
L_pc0:
    s_cmp_ge_u32 s57, s65
    s_cbranch_scc1 L_end
L_pc1:
    s_sub_u32 s46, s46, 1
    s_cbranch_scc1 L_end
    s_sleep 8
    ds_read_b32 v15, v13 offset:4
    s_waitcnt lgkmcnt(0)
    v_readfirstlane_b32 s71, v15
    s_nop 0
    s_cmp_lt_i32 s71, s57
    s_cbranch_scc1 L_pc1
    s_sub_u32 s74, s65, s71
    s_sub_u32 s54, 128, s74
    v_add_u32 v102, s54, v99
    s_mov_b64 exec, s[58:59]
    buffer_store_dword v102, v98, s[20:23], s56 offen
    s_mov_b64 exec, -1
    buffer_load_dword v100, v98, s[20:23], s56 offen sc1
    s_add_u32 s57, s71, 2
    s_sub_u32 s73, s74, 2
    s_min_i32 s73, s73, 24
    s_max_i32 s73, s73, 4
    v_cvt_f32_u32 v102, s73
    s_lshl_b32 s76, s54, 5
    s_sub_u32 s76, s76, 40
    v_rcp_f32 v102, v102
    s_waitcnt vmcnt(0)
    v_sub_u32 v101, v100, v99
    v_cmp_eq_u32 vcc, 0, v101
    s_nop 0
    v_add_u32_dpp v101, v101, v101 row_shr:1 row_mask:0xf bank_mask:0xf bound_ctrl:0
    s_nop 1
    v_add_u32_dpp v101, v101, v101 row_shr:2 row_mask:0xf bank_mask:0xf bound_ctrl:0
    s_nop 1
    v_add_u32_dpp v101, v101, v101 row_shr:4 row_mask:0xf bank_mask:0xf bound_ctrl:0
    s_nop 1
    v_add_u32_dpp v101, v101, v101 row_shr:8 row_mask:0xf bank_mask:0xf bound_ctrl:0
    s_nop 1
    v_add_u32_dpp v101, v101, v101 row_bcast:15 row_mask:0xa bank_mask:0xf
    s_cbranch_vccnz L_pc0
    v_mad_i32_i24 v101, v105, -6, v101
    v_subrev_u32 v101, s76, v101
    v_cvt_f32_i32 v101, v101
    v_mul_f32 v101, 0x3ec00000, v101
    v_mul_f32 v101, v101, v102
    v_rndne_f32 v101, v101
    v_cvt_i32_f32 v101, v101
    v_med3_i32 v101, v101, -6, 5
    v_mov_b32 v105, v101
    s_mov_b32 exec_lo, 0x80000000
    s_mov_b32 exec_hi, 0
    ds_write_b32 v5, v101
    s_mov_b64 exec, -1
    s_branch L_pc0
L_helper:
    s_waitcnt vmcnt(0)
    ds_read_b64 v[72:73], v4
    v_mov_b32 v64, 162304
    v_mov_b32 v65, 162816
    v_add_u32 v5, 162304, v239
    v_cndmask_b32 v66, v65, v64, vcc
    v_cmp_gt_u32 vcc, s65, v74
    v_mov_b32 v75, 1
    s_waitcnt lgkmcnt(0)
    v_bfe_u32 v64, v72, 5, 7
    v_bfe_u32 v65, v73, 5, 7
    v_lshl_add_u32 v64, v64, 2, v66
    v_lshl_add_u32 v65, v65, 2, v66
    s_mov_b64 s[48:49], vcc
    s_mov_b64 exec, vcc
    ds_add_rtn_u32 v66, v64, v75
    ds_add_rtn_u32 v67, v65, v75
    s_mov_b64 exec, -1
    ds_read_b128 v[68:71], v5
    v_lshlrev_b32 v72, 15, v72
    v_lshlrev_b32 v73, 15, v73
    s_waitcnt lgkmcnt(0)
    v_add_u32 v69, v68, v69
    v_add_u32 v70, v69, v70
    v_add_u32 v71, v70, v71
    v_mov_b32 v96, v71
    s_nop 1
    v_add_u32_dpp v96, v96, v96 row_shr:1 row_mask:0xf bank_mask:0xf bound_ctrl:0
    s_nop 1
    v_add_u32_dpp v96, v96, v96 row_shr:2 row_mask:0xf bank_mask:0xf bound_ctrl:0
    s_nop 1
    v_add_u32_dpp v96, v96, v96 row_shr:4 row_mask:0xf bank_mask:0xf bound_ctrl:0
    s_nop 1
    v_add_u32_dpp v96, v96, v96 row_shr:8 row_mask:0xf bank_mask:0xf bound_ctrl:0
    s_nop 1
    v_add_u32_dpp v96, v96, v96 row_bcast:15 row_mask:0xa bank_mask:0xf
    s_nop 1
    v_add_u32_dpp v96, v96, v96 row_bcast:31 row_mask:0xc bank_mask:0xf
    v_sub_u32 v96, v96, v71
    v_add_u32 v97, v96, v68
    v_add_u32 v98, v96, v69
    v_add_u32 v99, v96, v70
    ds_write_b128 v5, v[96:99]
    ds_read_b32 v64, v64
    ds_read_b32 v65, v65
    v_mov_b32 v5, 161792
    v_mov_b32 v4, 159232
    s_mov_b64 exec, s[48:49]
    s_waitcnt lgkmcnt(0)
    v_add_u32 v66, v66, v64
    v_add_u32 v67, v67, v65
    v_lshl_add_u32 v66, v66, 2, v5
    v_lshl_add_u32 v67, v67, 2, v5
    ds_write_b32 v66, v72
    ds_write_b32 v67, v73
    s_mov_b64 exec, -1
    ds_write_b32 v4, v75 offset:4
    s_setprio 0
    s_mov_b32 s82, 1
    s_cmp_eq_u32 s37, 0
    s_cselect_b32 s38, 0, s38
    s_lshl_b32 s73, s44, 2
    v_mov_b32 v90, s73
    s_getreg_b32 s73, hwreg(HW_REG_XCC_ID, 0, 4)
    s_or_b32 s76, s73, 16
    s_lshl_b32 s74, s33, 3
    s_lshl_b32 s73, s76, s74
    s_mul_i32 s83, s76, 0x01010101
    s_waitcnt vmcnt(0)
    v_mov_b32 v84, s73
    ds_write_b32 v14, v89 offset:1536
    s_mov_b64 exec, 1
    buffer_atomic_or v84, v90, s[28:31], 0 offen sc1
    s_mov_b64 exec, -1
    s_cmp_eq_u32 s38, 0
    s_cbranch_scc1 L_hq2
    s_mov_b32 s64, s36
    s_branch L_hfree_q
L_hfree0_q:
    s_sub_u32 s46, s46, 1
    s_cbranch_scc1 L_end
    s_sleep 16
L_hfree_q:
    ds_read_b32 v86, v87 offset:1536
    s_waitcnt lgkmcnt(0)
    v_readlane_b32 s73, v86, 0
    v_readlane_b32 s74, v86, 1
    v_readlane_b32 s75, v86, 2
    v_readlane_b32 s76, v86, 3
    s_min_u32 s73, s73, s74
    s_min_u32 s75, s75, s76
    s_min_u32 s73, s73, s75
    s_cmp_lt_u32 s73, s82
    s_cbranch_scc1 L_hfree0_q
    s_lshl_b32 s72, s64, 3
    s_add_u32 s72, s72, s32
    s_lshl_b32 s72, s72, 15
    s_xor_b32 s71, s72, s47
    s_mov_b32 m0, 121856
    s_nop 0
    buffer_load_dwordx4 v242, s[8:11], s71 offen offset:0 nt lds
    s_mov_b32 m0, 121920
    s_nop 0
    buffer_load_dwordx4 v242, s[8:11], s71 offen offset:1024 nt lds
    s_mov_b32 m0, 121984
    s_nop 0
    buffer_load_dwordx4 v242, s[8:11], s71 offen offset:2048 nt lds
    s_mov_b32 m0, 122048
    s_nop 0
    buffer_load_dwordx4 v242, s[8:11], s71 offen offset:3072 nt lds
    s_mov_b32 m0, 126208
    s_add_u32 s72, s72, 4096
    s_xor_b32 s71, s72, s47
    buffer_load_dwordx4 v242, s[8:11], s71 offen offset:0 nt lds
    s_mov_b32 m0, 126272
    s_nop 0
    buffer_load_dwordx4 v242, s[8:11], s71 offen offset:1024 nt lds
    s_mov_b32 m0, 126336
    s_nop 0
    buffer_load_dwordx4 v242, s[8:11], s71 offen offset:2048 nt lds
    s_mov_b32 m0, 126400
    s_nop 0
    buffer_load_dwordx4 v242, s[8:11], s71 offen offset:3072 nt lds
    s_mov_b32 m0, 130560
    s_add_u32 s72, s72, 4096
    s_xor_b32 s71, s72, s47
    buffer_load_dwordx4 v242, s[8:11], s71 offen offset:0 nt lds
    s_mov_b32 m0, 130624
    s_waitcnt vmcnt(7)
    buffer_load_dwordx4 v242, s[8:11], s71 offen offset:1024 nt lds
    s_mov_b32 m0, 130688
    s_waitcnt vmcnt(7)
    buffer_load_dwordx4 v242, s[8:11], s71 offen offset:2048 nt lds
    s_mov_b32 m0, 130752
    s_waitcnt vmcnt(7)
    buffer_load_dwordx4 v242, s[8:11], s71 offen offset:3072 nt lds
    s_mov_b32 m0, 134912
    s_add_u32 s72, s72, 4096
    s_xor_b32 s71, s72, s47
    buffer_load_dwordx4 v242, s[8:11], s71 offen offset:0 nt lds
    s_mov_b32 m0, 134976
    s_waitcnt vmcnt(7)
    buffer_load_dwordx4 v242, s[8:11], s71 offen offset:1024 nt lds
    s_mov_b32 m0, 135040
    s_waitcnt vmcnt(7)
    buffer_load_dwordx4 v242, s[8:11], s71 offen offset:2048 nt lds
    s_mov_b32 m0, 135104
    s_waitcnt vmcnt(7)
    buffer_load_dwordx4 v242, s[8:11], s71 offen offset:3072 nt lds
    s_mov_b32 m0, 139264
    s_add_u32 s72, s72, 4096
    s_xor_b32 s71, s72, s47
    buffer_load_dwordx4 v242, s[8:11], s71 offen offset:0 nt lds
    s_mov_b32 m0, 139328
    s_waitcnt vmcnt(7)
    buffer_load_dwordx4 v242, s[8:11], s71 offen offset:1024 nt lds
    s_mov_b32 m0, 139392
    s_waitcnt vmcnt(7)
    buffer_load_dwordx4 v242, s[8:11], s71 offen offset:2048 nt lds
    s_mov_b32 m0, 139456
    s_waitcnt vmcnt(7)
    buffer_load_dwordx4 v242, s[8:11], s71 offen offset:3072 nt lds
    s_mov_b32 m0, 143616
    s_add_u32 s72, s72, 4096
    s_xor_b32 s71, s72, s47
    buffer_load_dwordx4 v242, s[8:11], s71 offen offset:0 nt lds
    s_mov_b32 m0, 143680
    s_waitcnt vmcnt(7)
    buffer_load_dwordx4 v242, s[8:11], s71 offen offset:1024 nt lds
    s_mov_b32 m0, 143744
    s_waitcnt vmcnt(7)
    buffer_load_dwordx4 v242, s[8:11], s71 offen offset:2048 nt lds
    s_mov_b32 m0, 143808
    s_waitcnt vmcnt(7)
    buffer_load_dwordx4 v242, s[8:11], s71 offen offset:3072 nt lds
    s_mov_b32 m0, 147968
    s_add_u32 s72, s72, 4096
    s_xor_b32 s71, s72, s47
    buffer_load_dwordx4 v242, s[8:11], s71 offen offset:0 nt lds
    s_mov_b32 m0, 148032
    s_waitcnt vmcnt(7)
    buffer_load_dwordx4 v242, s[8:11], s71 offen offset:1024 nt lds
    s_mov_b32 m0, 148096
    s_waitcnt vmcnt(7)
    buffer_load_dwordx4 v242, s[8:11], s71 offen offset:2048 nt lds
    s_mov_b32 m0, 148160
    s_waitcnt vmcnt(7)
    buffer_load_dwordx4 v242, s[8:11], s71 offen offset:3072 nt lds
    s_mov_b32 m0, 152320
    s_add_u32 s72, s72, 4096
    s_xor_b32 s71, s72, s47
    buffer_load_dwordx4 v242, s[8:11], s71 offen offset:0 nt lds
    s_mov_b32 m0, 152384
    s_waitcnt vmcnt(7)
    buffer_load_dwordx4 v242, s[8:11], s71 offen offset:1024 nt lds
    s_mov_b32 m0, 152448
    s_waitcnt vmcnt(7)
    buffer_load_dwordx4 v242, s[8:11], s71 offen offset:2048 nt lds
    s_mov_b32 m0, 152512
    s_waitcnt vmcnt(7)
    buffer_load_dwordx4 v242, s[8:11], s71 offen offset:3072 nt lds
    v_mov_b32 v85, 1
    s_waitcnt vmcnt(0)
    ds_write_b32 v14, v85
L_hq2:
    s_lshr_b32 s80, s2, 3
    s_and_b32 s80, s80, 15
    s_add_u32 s70, s80, 10
    s_min_u32 s70, s70, s65
    s_branch L_hp_c
L_hp0_c:
    s_sub_u32 s46, s46, 1
    s_cbranch_scc1 L_end
    s_sleep 16
L_hp_c:
    ds_read_b32 v15, v13
    s_waitcnt lgkmcnt(0)
    v_readfirstlane_b32 s71, v15
    s_nop 0
    s_cmp_lt_u32 s71, s70
    s_cbranch_scc1 L_hp0_c
    s_branch L_hchk
L_hchk0:
    s_sub_u32 s46, s46, 1
    s_cbranch_scc1 L_end
    s_sleep 64
L_hchk:
    buffer_load_dword v91, v90, s[28:31], 0 offen sc1
    s_waitcnt vmcnt(0)
    v_readfirstlane_b32 s73, v91
    s_nop 0
    s_and_b32 s74, s73, 0x10101010
    s_cmp_eq_u32 s74, 0x10101010
    s_cbranch_scc0 L_hchk0
    s_cmp_eq_u32 s73, s83
    s_cselect_b32 s83, 1, 2
    v_mov_b32 v91, s83
    v_mov_b32 v4, 159232
    ds_write_b32 v4, v91
    s_cmp_eq_u32 s33, 1
    s_cbranch_scc0 L_hdone
    s_cmp_eq_u32 s37, 0
    s_cbranch_scc1 L_hdone
    s_mov_b32 s82, 2
    s_branch L_hfree_h
L_hfree0_h:
    s_sub_u32 s46, s46, 1
    s_cbranch_scc1 L_end
    s_sleep 16
L_hfree_h:
    ds_read_b32 v86, v87 offset:1536
    s_waitcnt lgkmcnt(0)
    v_readlane_b32 s73, v86, 0
    v_readlane_b32 s74, v86, 1
    v_readlane_b32 s75, v86, 2
    v_readlane_b32 s76, v86, 3
    s_min_u32 s73, s73, s74
    s_min_u32 s75, s75, s76
    s_min_u32 s73, s73, s75
    s_cmp_lt_u32 s73, s82
    s_cbranch_scc1 L_hfree0_h
    v_add_u32 v5, 121856, v239
    v_mul_u32_u24 v4, 8704, v2
    v_lshl_add_u32 v4, v3, 4, v4
    v_add_u32 v4, 130048, v4
    ds_read_b128 v[100:103], v5 offset:0
    ds_read_b128 v[104:107], v5 offset:1024
    ds_read_b128 v[108:111], v5 offset:2048
    ds_read_b128 v[112:115], v5 offset:3072
    ds_read_b128 v[116:119], v5 offset:4096
    ds_read_b128 v[120:123], v5 offset:5120
    ds_read_b128 v[124:127], v5 offset:6144
    ds_read_b128 v[128:131], v5 offset:7168
    ds_read_b128 v[132:135], v5 offset:8704
    ds_read_b128 v[136:139], v5 offset:9728
    ds_read_b128 v[140:143], v5 offset:10752
    ds_read_b128 v[144:147], v5 offset:11776
    ds_read_b128 v[148:151], v5 offset:12800
    ds_read_b128 v[152:155], v5 offset:13824
    ds_read_b128 v[156:159], v5 offset:14848
    ds_read_b128 v[160:163], v5 offset:15872
    ds_read_b128 v[164:167], v5 offset:17408
    ds_read_b128 v[168:171], v5 offset:18432
    ds_read_b128 v[172:175], v5 offset:19456
    ds_read_b128 v[176:179], v5 offset:20480
    ds_read_b128 v[180:183], v5 offset:21504
    ds_read_b128 v[184:187], v5 offset:22528
    ds_read_b128 v[188:191], v5 offset:23552
    ds_read_b128 v[192:195], v5 offset:24576
    ds_read_b128 v[196:199], v5 offset:26112
    ds_read_b128 v[200:203], v5 offset:27136
    ds_read_b128 v[204:207], v5 offset:28160
    ds_read_b128 v[208:211], v5 offset:29184
    ds_read_b128 v[212:215], v5 offset:30208
    ds_read_b128 v[216:219], v5 offset:31232
    ds_read_b128 v[220:223], v5 offset:32256
    ds_read_b128 v[224:227], v5 offset:33280
    ds_read_b128 v[228:231], v4
    s_mul_i32 s77, s44, 6
    s_add_u32 s77, s77, 4
    s_mul_i32 s77, s77, 17408
    v_lshrrev_b32 v4, 3, v3
    v_mul_u32_u24 v4, 17408, v4
    v_lshl_add_u32 v4, v2, 7, v4
    v_and_b32 v5, 7, v3
    v_lshl_add_u32 v4, v5, 4, v4
    v_add_u32 v89, 1, v89
    s_cmp_eq_u32 s83, 1
    s_cselect_b32 s73, 8, 1
    s_sub_u32 s70, s65, s73
    s_max_i32 s70, s70, 0
    s_branch L_hp_h
L_hp0_h:
    s_sub_u32 s46, s46, 1
    s_cbranch_scc1 L_end
    s_sleep 16
L_hp_h:
    ds_read_b32 v15, v13
    s_waitcnt lgkmcnt(0)
    v_readfirstlane_b32 s71, v15
    s_nop 0
    s_cmp_lt_u32 s71, s70
    s_cbranch_scc1 L_hp0_h
    s_cmp_eq_u32 s83, 1
    s_cbranch_scc0 L_hwt
    s_add_u32 s72, s77, 0
    buffer_store_dwordx4 v[100:103], v239, s[20:23], s72 offen offset:0
    buffer_store_dwordx4 v[104:107], v239, s[20:23], s72 offen offset:1024
    buffer_store_dwordx4 v[108:111], v239, s[20:23], s72 offen offset:2048
    buffer_store_dwordx4 v[112:115], v239, s[20:23], s72 offen offset:3072
    s_add_u32 s72, s77, 17408
    buffer_store_dwordx4 v[116:119], v239, s[20:23], s72 offen offset:0
    buffer_store_dwordx4 v[120:123], v239, s[20:23], s72 offen offset:1024
    buffer_store_dwordx4 v[124:127], v239, s[20:23], s72 offen offset:2048
    buffer_store_dwordx4 v[128:131], v239, s[20:23], s72 offen offset:3072
    s_add_u32 s72, s77, 4096
    buffer_store_dwordx4 v[132:135], v239, s[20:23], s72 offen offset:0
    buffer_store_dwordx4 v[136:139], v239, s[20:23], s72 offen offset:1024
    buffer_store_dwordx4 v[140:143], v239, s[20:23], s72 offen offset:2048
    buffer_store_dwordx4 v[144:147], v239, s[20:23], s72 offen offset:3072
    s_add_u32 s72, s77, 21504
    buffer_store_dwordx4 v[148:151], v239, s[20:23], s72 offen offset:0
    buffer_store_dwordx4 v[152:155], v239, s[20:23], s72 offen offset:1024
    buffer_store_dwordx4 v[156:159], v239, s[20:23], s72 offen offset:2048
    buffer_store_dwordx4 v[160:163], v239, s[20:23], s72 offen offset:3072
    s_add_u32 s72, s77, 8192
    buffer_store_dwordx4 v[164:167], v239, s[20:23], s72 offen offset:0
    buffer_store_dwordx4 v[168:171], v239, s[20:23], s72 offen offset:1024
    buffer_store_dwordx4 v[172:175], v239, s[20:23], s72 offen offset:2048
    buffer_store_dwordx4 v[176:179], v239, s[20:23], s72 offen offset:3072
    s_add_u32 s72, s77, 25600
    buffer_store_dwordx4 v[180:183], v239, s[20:23], s72 offen offset:0
    buffer_store_dwordx4 v[184:187], v239, s[20:23], s72 offen offset:1024
    buffer_store_dwordx4 v[188:191], v239, s[20:23], s72 offen offset:2048
    buffer_store_dwordx4 v[192:195], v239, s[20:23], s72 offen offset:3072
    s_add_u32 s72, s77, 12288
    buffer_store_dwordx4 v[196:199], v239, s[20:23], s72 offen offset:0
    buffer_store_dwordx4 v[200:203], v239, s[20:23], s72 offen offset:1024
    buffer_store_dwordx4 v[204:207], v239, s[20:23], s72 offen offset:2048
    buffer_store_dwordx4 v[208:211], v239, s[20:23], s72 offen offset:3072
    s_add_u32 s72, s77, 29696
    buffer_store_dwordx4 v[212:215], v239, s[20:23], s72 offen offset:0
    buffer_store_dwordx4 v[216:219], v239, s[20:23], s72 offen offset:1024
    buffer_store_dwordx4 v[220:223], v239, s[20:23], s72 offen offset:2048
    buffer_store_dwordx4 v[224:227], v239, s[20:23], s72 offen offset:3072
    s_add_u32 s71, s77, 16384
    buffer_store_dwordx4 v[228:231], v4, s[20:23], s71 offen
    s_mov_b64 exec, 0xff0000
    s_waitcnt vmcnt(0)
    buffer_store_dword v89, v92, s[20:23], 0 offen
    s_mov_b64 exec, -1
    s_branch L_hdone
L_hwt:
    s_add_u32 s72, s77, 0
    buffer_store_dwordx4 v[100:103], v239, s[20:23], s72 offen offset:0 sc1
    buffer_store_dwordx4 v[104:107], v239, s[20:23], s72 offen offset:1024 sc1
    buffer_store_dwordx4 v[108:111], v239, s[20:23], s72 offen offset:2048 sc1
    buffer_store_dwordx4 v[112:115], v239, s[20:23], s72 offen offset:3072 sc1
    s_add_u32 s72, s77, 17408
    buffer_store_dwordx4 v[116:119], v239, s[20:23], s72 offen offset:0 sc1
    buffer_store_dwordx4 v[120:123], v239, s[20:23], s72 offen offset:1024 sc1
    buffer_store_dwordx4 v[124:127], v239, s[20:23], s72 offen offset:2048 sc1
    buffer_store_dwordx4 v[128:131], v239, s[20:23], s72 offen offset:3072 sc1
    s_add_u32 s72, s77, 4096
    buffer_store_dwordx4 v[132:135], v239, s[20:23], s72 offen offset:0 sc1
    buffer_store_dwordx4 v[136:139], v239, s[20:23], s72 offen offset:1024 sc1
    buffer_store_dwordx4 v[140:143], v239, s[20:23], s72 offen offset:2048 sc1
    buffer_store_dwordx4 v[144:147], v239, s[20:23], s72 offen offset:3072 sc1
    s_add_u32 s72, s77, 21504
    buffer_store_dwordx4 v[148:151], v239, s[20:23], s72 offen offset:0 sc1
    buffer_store_dwordx4 v[152:155], v239, s[20:23], s72 offen offset:1024 sc1
    buffer_store_dwordx4 v[156:159], v239, s[20:23], s72 offen offset:2048 sc1
    buffer_store_dwordx4 v[160:163], v239, s[20:23], s72 offen offset:3072 sc1
    s_add_u32 s72, s77, 8192
    buffer_store_dwordx4 v[164:167], v239, s[20:23], s72 offen offset:0 sc1
    buffer_store_dwordx4 v[168:171], v239, s[20:23], s72 offen offset:1024 sc1
    buffer_store_dwordx4 v[172:175], v239, s[20:23], s72 offen offset:2048 sc1
    buffer_store_dwordx4 v[176:179], v239, s[20:23], s72 offen offset:3072 sc1
    s_add_u32 s72, s77, 25600
    buffer_store_dwordx4 v[180:183], v239, s[20:23], s72 offen offset:0 sc1
    buffer_store_dwordx4 v[184:187], v239, s[20:23], s72 offen offset:1024 sc1
    buffer_store_dwordx4 v[188:191], v239, s[20:23], s72 offen offset:2048 sc1
    buffer_store_dwordx4 v[192:195], v239, s[20:23], s72 offen offset:3072 sc1
    s_add_u32 s72, s77, 12288
    buffer_store_dwordx4 v[196:199], v239, s[20:23], s72 offen offset:0 sc1
    buffer_store_dwordx4 v[200:203], v239, s[20:23], s72 offen offset:1024 sc1
    buffer_store_dwordx4 v[204:207], v239, s[20:23], s72 offen offset:2048 sc1
    buffer_store_dwordx4 v[208:211], v239, s[20:23], s72 offen offset:3072 sc1
    s_add_u32 s72, s77, 29696
    buffer_store_dwordx4 v[212:215], v239, s[20:23], s72 offen offset:0 sc1
    buffer_store_dwordx4 v[216:219], v239, s[20:23], s72 offen offset:1024 sc1
    buffer_store_dwordx4 v[220:223], v239, s[20:23], s72 offen offset:2048 sc1
    buffer_store_dwordx4 v[224:227], v239, s[20:23], s72 offen offset:3072 sc1
    s_add_u32 s71, s77, 16384
    buffer_store_dwordx4 v[228:231], v4, s[20:23], s71 offen sc1
    s_mov_b64 exec, 0xff0000
    s_waitcnt vmcnt(0)
    buffer_store_dword v89, v92, s[20:23], 0 offen sc1
    s_mov_b64 exec, -1
L_hdone:
    s_endpgm
L_consumer:
    v_lshlrev_b32 v240, 2, v2
    v_lshrrev_b32 v4, 2, v3
    v_mul_u32_u24 v4, 1088, v4
    v_and_b32 v5, 3, v3
    v_lshl_add_u32 v6, v5, 8, v4
    v_xor_b32 v248, v5, v2
    v_lshl_add_u32 v6, v248, 4, v6
    v_lshl_add_u32 v4, v2, 8, v4
    v_lshl_add_u32 v4, v5, 3, v4
    v_add_u32 v4, 8704, v4
    v_and_b32 v248, 1, v2
    v_lshl_add_u32 v7, v248, 5, v4
    v_xor_b32 v8, 32, v7
    v_lshlrev_b32 v12, 8, v3
    v_lshl_add_u32 v12, v248, 5, v12
    v_lshrrev_b32 v248, 1, v2
    v_lshl_add_u32 v12, v248, 4, v12
    v_mov_b32 v232, 0x3f803f80
    v_mov_b32 v233, 0x3f803f80
    v_mov_b32 v234, 0x3f803f80
    v_mov_b32 v235, 0x3f803f80
    v_lshlrev_b32 v243, 3, v3
    v_mov_b32 v241, 0
    s_mov_b32 s66, 0
    s_mov_b32 s68, 0
    s_mov_b32 s82, 0
    s_mov_b32 s61, 17408
    s_mov_b32 s62, 121856
    s_mov_b32 s63, 0x41000000
    s_bitcmp1_b32 s33, 0
    s_cselect_b32 s51, s36, s35
    s_lshl_b32 s51, s51, 3
    s_add_u32 s51, s51, s32
    s_lshl_b32 s51, s51, 2
    s_add_u32 s51, s51, s3
    s_lshl_b32 s51, s51, 13
    s_add_u32 s51, s51, s47
    s_mul_i32 s58, s44, 6
    s_add_u32 s58, s58, s33
    s_mul_i32 s58, s58, 17408
    s_lshl_b32 s75, s3, 12
    s_lshl_b32 s76, s3, 7
    s_add_u32 s76, s76, 16384
    s_add_u32 s50, s76, 512
    s_xor_b32 s48, s51, 4096
    s_add_u32 s49, s58, s76
    s_xor_b32 s59, s33, 2
    s_lshr_b32 s60, s33, 1
    s_add_u32 s60, s60, 4
    s_cmp_eq_u32 s42, 0
    s_cselect_b32 s60, s59, s60
    s_mul_i32 s52, s44, 6
    s_add_u32 s52, s52, s59
    s_mul_i32 s52, s52, 17408
    s_mul_i32 s53, s44, 6
    s_add_u32 s53, s53, s60
    s_mul_i32 s53, s53, 17408
    s_add_u32 s54, s52, s76
    s_add_u32 s55, s53, s76
    s_add_u32 s57, s53, s75
    s_mov_b32 s56, s51
    v_mov_b32 v247, s33
    v_writelane_b32 v247, s59, 0
    v_writelane_b32 v247, s60, 1
    v_mov_b32 v246, s58
    v_writelane_b32 v246, s52, 0
    v_writelane_b32 v246, s53, 1
    s_lshl_b32 s73, s3, 2
    s_add_u32 s73, s73, 159488
    v_lshl_add_u32 v247, v247, 4, s73
    v_mov_b32 v56, 0
    v_mov_b32 v57, 0
    v_mov_b32 v58, 0
    v_mov_b32 v59, 0
    v_mov_b32 v60, 0
    v_mov_b32 v61, 0
    v_mov_b32 v62, 0
    v_mov_b32 v63, 0
    v_mov_b32 v64, 0
    v_mov_b32 v65, 0
    v_mov_b32 v66, 0
    v_mov_b32 v67, 0
    v_mov_b32 v68, 0
    v_mov_b32 v69, 0
    v_mov_b32 v70, 0
    v_mov_b32 v71, 0
    v_mov_b32 v72, 0
    v_mov_b32 v73, 0
    v_mov_b32 v74, 0
    v_mov_b32 v75, 0
    v_mov_b32 v76, 0
    v_mov_b32 v77, 0
    v_mov_b32 v78, 0
    v_mov_b32 v79, 0
    v_mov_b32 v80, 0
    v_mov_b32 v81, 0
    v_mov_b32 v82, 0
    v_mov_b32 v83, 0
    v_mov_b32 v84, 0
    v_mov_b32 v85, 0
    v_mov_b32 v86, 0
    v_mov_b32 v87, 0
    v_mov_b32 v88, 0
    v_mov_b32 v89, 0
    v_mov_b32 v90, 0
    v_mov_b32 v91, 0
    v_mov_b32 v92, 0
    v_mov_b32 v93, 0
    v_mov_b32 v94, 0
    v_mov_b32 v95, 0
    v_mov_b32 v96, 0
    v_mov_b32 v97, 0
    v_mov_b32 v98, 0
    v_mov_b32 v99, 0
    v_mov_b32 v100, 0
    v_mov_b32 v101, 0
    v_mov_b32 v102, 0
    v_mov_b32 v103, 0
    v_mov_b32 v104, 0
    v_mov_b32 v105, 0
    v_mov_b32 v106, 0
    v_mov_b32 v107, 0
    v_mov_b32 v108, 0
    v_mov_b32 v109, 0
    v_mov_b32 v110, 0
    v_mov_b32 v111, 0
    v_mov_b32 v112, 0
    v_mov_b32 v113, 0
    v_mov_b32 v114, 0
    v_mov_b32 v115, 0
    v_mov_b32 v116, 0
    v_mov_b32 v117, 0
    v_mov_b32 v118, 0
    v_mov_b32 v119, 0
    v_mov_b32 v120, 0
    v_mov_b32 v121, 0
    v_mov_b32 v122, 0
    v_mov_b32 v123, 0
    v_mov_b32 v124, 0
    v_mov_b32 v125, 0
    v_mov_b32 v126, 0
    v_mov_b32 v127, 0
    s_cmp_eq_u32 s37, 0
    s_cselect_b32 s73, s36, s35
    s_cmp_eq_u32 s73, s64
    s_cbranch_scc1 L_qok
    s_mov_b32 s64, s73
    s_lshl_b32 s77, s64, 3
    s_add_u32 s77, s77, s32
    s_lshl_b32 s77, s77, 2
    s_add_u32 s77, s77, s3
    s_lshl_b32 s77, s77, 13
    s_add_u32 s77, s77, s47
    s_xor_b32 s78, s77, 4096
    s_waitcnt vmcnt(0)
    s_add_u32 m0, s81, 0
    s_nop 0
    buffer_load_dwordx4 v242, s[8:11], s77 offen offset:0 nt lds
    s_add_u32 m0, s81, 64
    s_nop 0
    buffer_load_dwordx4 v242, s[8:11], s77 offen offset:1024 nt lds
    s_add_u32 m0, s81, 128
    s_nop 0
    buffer_load_dwordx4 v242, s[8:11], s77 offen offset:2048 nt lds
    s_add_u32 m0, s81, 192
    s_nop 0
    buffer_load_dwordx4 v242, s[8:11], s77 offen offset:3072 nt lds
    s_add_u32 m0, s81, 4352
    s_nop 0
    buffer_load_dwordx4 v242, s[8:11], s78 offen offset:0 nt lds
    s_add_u32 m0, s81, 4416
    s_nop 0
    buffer_load_dwordx4 v242, s[8:11], s78 offen offset:1024 nt lds
    s_add_u32 m0, s81, 4480
    s_nop 0
    buffer_load_dwordx4 v242, s[8:11], s78 offen offset:2048 nt lds
    s_add_u32 m0, s81, 4544
    s_nop 0
    buffer_load_dwordx4 v242, s[8:11], s78 offen offset:3072 nt lds
L_qok:
    s_cmp_eq_u32 s37, 0
    s_cbranch_scc1 L_segB
    s_mov_b32 s65, s37
    s_bitcmp1_b32 s43, 0
    s_branch L_seg
L_segB:
    s_cmp_eq_u32 s38, 0
    s_cbranch_scc1 L_empty
    s_mov_b32 s64, s36
    s_mov_b32 s65, s38
    s_mov_b32 s37, 0
    s_bitcmp1_b32 s43, 1
L_seg:
    s_cselect_b32 s72, 0, 0x3e0293ee
    s_add_u32 s67, s66, s65
    s_add_u32 s70, s66, 1
    s_cmp_eq_u32 s33, 1
    s_cselect_b32 s69, s37, 0
    v_add_u32 v9, s81, v6
    v_mov_b32 v244, s72
    s_cmp_eq_u32 s66, 0
    s_cbranch_scc0 L_hold
    s_waitcnt vmcnt(0)
    ds_read_b128 v[128:131], v9 offset:0
    ds_read_b128 v[132:135], v9 offset:4352
    ds_read_b128 v[136:139], v9 offset:64
    ds_read_b128 v[140:143], v9 offset:4416
    ds_read_b128 v[144:147], v9 offset:128
    ds_read_b128 v[148:151], v9 offset:4480
    ds_read_b128 v[152:155], v9 offset:192
    ds_read_b128 v[156:159], v9 offset:4544
L_nohold:
    v_add_u32 v241, 1, v241
    ds_write_b32 v14, v241 offset:1536
    v_add_u32 v9, s68, v6
    v_mov_b32 v238, s70
    s_add_u32 s68, s68, 17408
    s_cmp_ge_u32 s68, 121856
    s_cselect_b32 s68, 0, s68
    s_waitcnt lgkmcnt(8)
    v_lshlrev_b32 v248, 16, v128
    v_and_b32 v249, 0xffff0000, v128
    v_lshlrev_b32 v250, 16, v129
    v_and_b32 v251, 0xffff0000, v129
    v_lshlrev_b32 v252, 16, v130
    v_and_b32 v253, 0xffff0000, v130
    v_lshlrev_b32 v254, 16, v131
    v_and_b32 v255, 0xffff0000, v131
    v_pk_mul_f32 v[248:249], v[248:249], v[244:245] op_sel_hi:[1,0]
    v_pk_mul_f32 v[250:251], v[250:251], v[244:245] op_sel_hi:[1,0]
    v_pk_mul_f32 v[252:253], v[252:253], v[244:245] op_sel_hi:[1,0]
    v_pk_mul_f32 v[254:255], v[254:255], v[244:245] op_sel_hi:[1,0]
    v_cvt_pk_bf16_f32 v128, v248, v249
    v_cvt_pk_bf16_f32 v129, v250, v251
    v_cvt_pk_bf16_f32 v130, v252, v253
    v_cvt_pk_bf16_f32 v131, v254, v255
    s_waitcnt lgkmcnt(7)
    v_lshlrev_b32 v248, 16, v132
    v_and_b32 v249, 0xffff0000, v132
    v_lshlrev_b32 v250, 16, v133
    v_and_b32 v251, 0xffff0000, v133
    v_lshlrev_b32 v252, 16, v134
    v_and_b32 v253, 0xffff0000, v134
    v_lshlrev_b32 v254, 16, v135
    v_and_b32 v255, 0xffff0000, v135
    v_pk_mul_f32 v[248:249], v[248:249], v[244:245] op_sel_hi:[1,0]
    v_pk_mul_f32 v[250:251], v[250:251], v[244:245] op_sel_hi:[1,0]
    v_pk_mul_f32 v[252:253], v[252:253], v[244:245] op_sel_hi:[1,0]
    v_pk_mul_f32 v[254:255], v[254:255], v[244:245] op_sel_hi:[1,0]
    v_cvt_pk_bf16_f32 v132, v248, v249
    v_cvt_pk_bf16_f32 v133, v250, v251
    v_cvt_pk_bf16_f32 v134, v252, v253
    v_cvt_pk_bf16_f32 v135, v254, v255
    s_waitcnt lgkmcnt(6)
    v_lshlrev_b32 v248, 16, v136
    v_and_b32 v249, 0xffff0000, v136
    v_lshlrev_b32 v250, 16, v137
    v_and_b32 v251, 0xffff0000, v137
    v_lshlrev_b32 v252, 16, v138
    v_and_b32 v253, 0xffff0000, v138
    v_lshlrev_b32 v254, 16, v139
    v_and_b32 v255, 0xffff0000, v139
    v_pk_mul_f32 v[248:249], v[248:249], v[244:245] op_sel_hi:[1,0]
    v_pk_mul_f32 v[250:251], v[250:251], v[244:245] op_sel_hi:[1,0]
    v_pk_mul_f32 v[252:253], v[252:253], v[244:245] op_sel_hi:[1,0]
    v_pk_mul_f32 v[254:255], v[254:255], v[244:245] op_sel_hi:[1,0]
    v_cvt_pk_bf16_f32 v136, v248, v249
    v_cvt_pk_bf16_f32 v137, v250, v251
    v_cvt_pk_bf16_f32 v138, v252, v253
    v_cvt_pk_bf16_f32 v139, v254, v255
    s_waitcnt lgkmcnt(5)
    v_lshlrev_b32 v248, 16, v140
    v_and_b32 v249, 0xffff0000, v140
    v_lshlrev_b32 v250, 16, v141
    v_and_b32 v251, 0xffff0000, v141
    v_lshlrev_b32 v252, 16, v142
    v_and_b32 v253, 0xffff0000, v142
    v_lshlrev_b32 v254, 16, v143
    v_and_b32 v255, 0xffff0000, v143
    v_pk_mul_f32 v[248:249], v[248:249], v[244:245] op_sel_hi:[1,0]
    v_pk_mul_f32 v[250:251], v[250:251], v[244:245] op_sel_hi:[1,0]
    v_pk_mul_f32 v[252:253], v[252:253], v[244:245] op_sel_hi:[1,0]
    v_pk_mul_f32 v[254:255], v[254:255], v[244:245] op_sel_hi:[1,0]
    v_cvt_pk_bf16_f32 v140, v248, v249
    v_cvt_pk_bf16_f32 v141, v250, v251
    v_cvt_pk_bf16_f32 v142, v252, v253
    v_cvt_pk_bf16_f32 v143, v254, v255
    s_waitcnt lgkmcnt(4)
    v_lshlrev_b32 v248, 16, v144
    v_and_b32 v249, 0xffff0000, v144
    v_lshlrev_b32 v250, 16, v145
    v_and_b32 v251, 0xffff0000, v145
    v_lshlrev_b32 v252, 16, v146
    v_and_b32 v253, 0xffff0000, v146
    v_lshlrev_b32 v254, 16, v147
    v_and_b32 v255, 0xffff0000, v147
    v_pk_mul_f32 v[248:249], v[248:249], v[244:245] op_sel_hi:[1,0]
    v_pk_mul_f32 v[250:251], v[250:251], v[244:245] op_sel_hi:[1,0]
    v_pk_mul_f32 v[252:253], v[252:253], v[244:245] op_sel_hi:[1,0]
    v_pk_mul_f32 v[254:255], v[254:255], v[244:245] op_sel_hi:[1,0]
    v_cvt_pk_bf16_f32 v144, v248, v249
    v_cvt_pk_bf16_f32 v145, v250, v251
    v_cvt_pk_bf16_f32 v146, v252, v253
    v_cvt_pk_bf16_f32 v147, v254, v255
    s_waitcnt lgkmcnt(3)
    v_lshlrev_b32 v248, 16, v148
    v_and_b32 v249, 0xffff0000, v148
    v_lshlrev_b32 v250, 16, v149
    v_and_b32 v251, 0xffff0000, v149
    v_lshlrev_b32 v252, 16, v150
    v_and_b32 v253, 0xffff0000, v150
    v_lshlrev_b32 v254, 16, v151
    v_and_b32 v255, 0xffff0000, v151
    v_pk_mul_f32 v[248:249], v[248:249], v[244:245] op_sel_hi:[1,0]
    v_pk_mul_f32 v[250:251], v[250:251], v[244:245] op_sel_hi:[1,0]
    v_pk_mul_f32 v[252:253], v[252:253], v[244:245] op_sel_hi:[1,0]
    v_pk_mul_f32 v[254:255], v[254:255], v[244:245] op_sel_hi:[1,0]
    v_cvt_pk_bf16_f32 v148, v248, v249
    v_cvt_pk_bf16_f32 v149, v250, v251
    v_cvt_pk_bf16_f32 v150, v252, v253
    v_cvt_pk_bf16_f32 v151, v254, v255
    s_waitcnt lgkmcnt(2)
    v_lshlrev_b32 v248, 16, v152
    v_and_b32 v249, 0xffff0000, v152
    v_lshlrev_b32 v250, 16, v153
    v_and_b32 v251, 0xffff0000, v153
    v_lshlrev_b32 v252, 16, v154
    v_and_b32 v253, 0xffff0000, v154
    v_lshlrev_b32 v254, 16, v155
    v_and_b32 v255, 0xffff0000, v155
    v_pk_mul_f32 v[248:249], v[248:249], v[244:245] op_sel_hi:[1,0]
    v_pk_mul_f32 v[250:251], v[250:251], v[244:245] op_sel_hi:[1,0]
    v_pk_mul_f32 v[252:253], v[252:253], v[244:245] op_sel_hi:[1,0]
    v_pk_mul_f32 v[254:255], v[254:255], v[244:245] op_sel_hi:[1,0]
    v_cvt_pk_bf16_f32 v152, v248, v249
    v_cvt_pk_bf16_f32 v153, v250, v251
    v_cvt_pk_bf16_f32 v154, v252, v253
    v_cvt_pk_bf16_f32 v155, v254, v255
    s_waitcnt lgkmcnt(1)
    v_lshlrev_b32 v248, 16, v156
    v_and_b32 v249, 0xffff0000, v156
    v_lshlrev_b32 v250, 16, v157
    v_and_b32 v251, 0xffff0000, v157
    v_lshlrev_b32 v252, 16, v158
    v_and_b32 v253, 0xffff0000, v158
    v_lshlrev_b32 v254, 16, v159
    v_and_b32 v255, 0xffff0000, v159
    v_pk_mul_f32 v[248:249], v[248:249], v[244:245] op_sel_hi:[1,0]
    v_pk_mul_f32 v[250:251], v[250:251], v[244:245] op_sel_hi:[1,0]
    v_pk_mul_f32 v[252:253], v[252:253], v[244:245] op_sel_hi:[1,0]
    v_pk_mul_f32 v[254:255], v[254:255], v[244:245] op_sel_hi:[1,0]
    v_cvt_pk_bf16_f32 v156, v248, v249
    v_cvt_pk_bf16_f32 v157, v250, v251
    v_cvt_pk_bf16_f32 v158, v252, v253
    v_cvt_pk_bf16_f32 v159, v254, v255
L_spin_p0:
    s_sub_u32 s46, s46, 1
    s_cbranch_scc1 L_end
    ds_read_b32 v15, v13 offset:0
    s_waitcnt lgkmcnt(0)
    v_readfirstlane_b32 s71, v15
    s_nop 0
    s_cmp_lt_u32 s71, s70
    s_cbranch_scc1 L_spin_p0
    ds_read_b128 v[160:163], v9 offset:0
    ds_read_b128 v[164:167], v9 offset:4352
    ds_read_b128 v[168:171], v9 offset:64
    ds_read_b128 v[172:175], v9 offset:4416
    ds_read_b128 v[176:179], v9 offset:128
    ds_read_b128 v[180:183], v9 offset:4480
    ds_read_b128 v[184:187], v9 offset:192
    ds_read_b128 v[188:191], v9 offset:4544
    ds_write_b32 v14, v238
    s_add_u32 s70, s66, 2
    s_min_u32 s70, s70, s67
    v_sub_u32 v4, s41, v240
    v_mov_b32 v5, 0xff800000
    s_waitcnt lgkmcnt(8)
    v_mfma_f32_16x16x32_bf16 v[16:19], v[160:163], v[128:131], 0
    v_mfma_f32_16x16x32_bf16 v[24:27], v[160:163], v[132:135], 0
    s_waitcnt lgkmcnt(7)
    v_mfma_f32_16x16x32_bf16 v[20:23], v[164:167], v[128:131], 0
    v_mfma_f32_16x16x32_bf16 v[28:31], v[164:167], v[132:135], 0
    s_waitcnt lgkmcnt(6)
    v_mfma_f32_16x16x32_bf16 v[16:19], v[168:171], v[136:139], v[16:19]
    v_mfma_f32_16x16x32_bf16 v[24:27], v[168:171], v[140:143], v[24:27]
    s_waitcnt lgkmcnt(5)
    v_mfma_f32_16x16x32_bf16 v[20:23], v[172:175], v[136:139], v[20:23]
    v_mfma_f32_16x16x32_bf16 v[28:31], v[172:175], v[140:143], v[28:31]
    s_waitcnt lgkmcnt(4)
    v_mfma_f32_16x16x32_bf16 v[16:19], v[176:179], v[144:147], v[16:19]
    v_mfma_f32_16x16x32_bf16 v[24:27], v[176:179], v[148:151], v[24:27]
    s_waitcnt lgkmcnt(3)
    v_mfma_f32_16x16x32_bf16 v[20:23], v[180:183], v[144:147], v[20:23]
    v_mfma_f32_16x16x32_bf16 v[28:31], v[180:183], v[148:151], v[28:31]
    s_waitcnt lgkmcnt(2)
    v_mfma_f32_16x16x32_bf16 v[16:19], v[184:187], v[152:155], v[16:19]
    v_mfma_f32_16x16x32_bf16 v[24:27], v[184:187], v[156:159], v[24:27]
    s_waitcnt lgkmcnt(1)
    v_mfma_f32_16x16x32_bf16 v[20:23], v[188:191], v[152:155], v[20:23]
    v_mfma_f32_16x16x32_bf16 v[28:31], v[188:191], v[156:159], v[28:31]
    v_add_u32 v9, s68, v6
    v_add_u32 v10, s68, v7
    v_add_u32 v11, s68, v8
L_spin_p1:
    s_sub_u32 s46, s46, 1
    s_cbranch_scc1 L_end
    ds_read_b32 v15, v13 offset:0
    s_waitcnt lgkmcnt(0)
    v_readfirstlane_b32 s71, v15
    s_nop 0
    s_cmp_lt_u32 s71, s70
    s_cbranch_scc1 L_spin_p1
    ds_read_b128 v[160:163], v9 offset:0
    ds_read_b128 v[164:167], v9 offset:4352
    ds_read_b128 v[168:171], v9 offset:64
    ds_read_b128 v[172:175], v9 offset:4416
    ds_read_b128 v[176:179], v9 offset:128
    ds_read_b128 v[180:183], v9 offset:4480
    ds_read_b128 v[184:187], v9 offset:192
    ds_read_b128 v[188:191], v9 offset:4544
    s_cmp_eq_u32 s41, 32
    s_cbranch_scc1 L_nomask
    v_cmp_lt_i32 vcc, 0, v4
    s_nop 1
    v_cndmask_b32 v16, v5, v16, vcc
    v_cndmask_b32 v24, v5, v24, vcc
    v_cmp_lt_i32 vcc, 1, v4
    s_nop 1
    v_cndmask_b32 v17, v5, v17, vcc
    v_cndmask_b32 v25, v5, v25, vcc
    v_cmp_lt_i32 vcc, 2, v4
    s_nop 1
    v_cndmask_b32 v18, v5, v18, vcc
    v_cndmask_b32 v26, v5, v26, vcc
    v_cmp_lt_i32 vcc, 3, v4
    s_nop 1
    v_cndmask_b32 v19, v5, v19, vcc
    v_cndmask_b32 v27, v5, v27, vcc
    v_cmp_lt_i32 vcc, 16, v4
    s_nop 1
    v_cndmask_b32 v20, v5, v20, vcc
    v_cndmask_b32 v28, v5, v28, vcc
    v_cmp_lt_i32 vcc, 17, v4
    s_nop 1
    v_cndmask_b32 v21, v5, v21, vcc
    v_cndmask_b32 v29, v5, v29, vcc
    v_cmp_lt_i32 vcc, 18, v4
    s_nop 1
    v_cndmask_b32 v22, v5, v22, vcc
    v_cndmask_b32 v30, v5, v30, vcc
    v_cmp_lt_i32 vcc, 19, v4
    s_nop 1
    v_cndmask_b32 v23, v5, v23, vcc
    v_cndmask_b32 v31, v5, v31, vcc
L_nomask:
    v_max3_f32 v236, v16, v17, v18
    v_max3_f32 v237, v24, v25, v26
    v_max3_f32 v236, v236, v19, v20
    v_max3_f32 v237, v237, v27, v28
    v_max3_f32 v236, v236, v21, v22
    v_max3_f32 v237, v237, v29, v30
    v_max_f32 v236, v236, v23
    v_max_f32 v237, v237, v31
    v_mov_b32 v2, v236
    v_mov_b32 v3, v237
    s_nop 0
    v_permlane32_swap_b32 v236, v2
    v_permlane32_swap_b32 v237, v3
    s_nop 0
    v_max_f32 v236, v236, v2
    v_max_f32 v237, v237, v3
    v_mov_b32 v2, v236
    v_mov_b32 v3, v237
    s_nop 0
    v_permlane16_swap_b32 v236, v2
    v_permlane16_swap_b32 v237, v3
    s_nop 0
    v_max_f32 v236, v236, v2
    v_max_f32 v237, v237, v3
    v_ceil_f32 v236, v236
    v_ceil_f32 v237, v237
    v_sub_f32 v48, 0, v236
    v_sub_f32 v49, 0, v236
    v_sub_f32 v50, 0, v236
    v_sub_f32 v51, 0, v236
    v_sub_f32 v52, 0, v237
    v_sub_f32 v53, 0, v237
    v_sub_f32 v54, 0, v237
    v_sub_f32 v55, 0, v237
    v_sub_f32 v32, v16, v236
    v_sub_f32 v33, v17, v236
    v_sub_f32 v34, v18, v236
    v_sub_f32 v35, v19, v236
    v_sub_f32 v36, v20, v236
    v_sub_f32 v37, v21, v236
    v_sub_f32 v38, v22, v236
    v_sub_f32 v39, v23, v236
    v_sub_f32 v40, v24, v237
    v_sub_f32 v41, v25, v237
    v_sub_f32 v42, v26, v237
    v_sub_f32 v43, v27, v237
    v_sub_f32 v44, v28, v237
    v_sub_f32 v45, v29, v237
    v_sub_f32 v46, v30, v237
    v_sub_f32 v47, v31, v237
    v_exp_f32 v32, v32
    v_exp_f32 v33, v33
    v_exp_f32 v34, v34
    v_exp_f32 v35, v35
    v_exp_f32 v36, v36
    v_exp_f32 v37, v37
    v_exp_f32 v38, v38
    v_exp_f32 v39, v39
    v_exp_f32 v40, v40
    v_exp_f32 v41, v41
    v_exp_f32 v42, v42
    v_exp_f32 v43, v43
    v_exp_f32 v44, v44
    v_exp_f32 v45, v45
    v_exp_f32 v46, v46
    v_exp_f32 v47, v47
    s_waitcnt lgkmcnt(0)
    s_sub_u32 s80, s65, 2
    s_cbranch_scc1 L_final
.p2align 3
L_loop:
    v_mfma_f32_16x16x32_bf16 v[16:19], v[160:163], v[128:131], v[48:51]
    s_add_u32 s70, s70, 1
    ds_read_b64_tr_b16 v[192:193], v10 offset:0
    v_cvt_pk_bf16_f32 v224, v32, v33
    v_mfma_f32_16x16x32_bf16 v[24:27], v[160:163], v[132:135], v[52:55]
    s_sub_u32 s80, s80, 1
    ds_read_b64_tr_b16 v[194:195], v10 offset:4352
    v_cvt_pk_bf16_f32 v225, v34, v35
    v_mfma_f32_16x16x32_bf16 v[16:19], v[168:171], v[136:139], v[16:19]
    s_cselect_b32 s73, -1, s70
    ds_read_b64_tr_b16 v[196:197], v11 offset:0
    v_cvt_pk_bf16_f32 v228, v40, v41
    v_mfma_f32_16x16x32_bf16 v[24:27], v[168:171], v[140:143], v[24:27]
    s_add_u32 s68, s68, s61
    ds_read_b64_tr_b16 v[198:199], v11 offset:4352
    v_cvt_pk_bf16_f32 v229, v42, v43
    v_mfma_f32_16x16x32_bf16 v[16:19], v[176:179], v[144:147], v[16:19]
    s_cmp_ge_u32 s68, s62
    ds_read_b64_tr_b16 v[200:201], v10 offset:64
    v_cvt_pk_bf16_f32 v226, v36, v37
    v_mfma_f32_16x16x32_bf16 v[24:27], v[176:179], v[148:151], v[24:27]
    s_cselect_b32 s68, 0, s68
    ds_read_b64_tr_b16 v[202:203], v10 offset:4416
    v_cvt_pk_bf16_f32 v227, v38, v39
    v_mfma_f32_16x16x32_bf16 v[16:19], v[184:187], v[152:155], v[16:19]
    ds_read_b64_tr_b16 v[204:205], v11 offset:64
    v_cvt_pk_bf16_f32 v230, v44, v45
    v_mfma_f32_16x16x32_bf16 v[24:27], v[184:187], v[156:159], v[24:27]
    s_waitcnt lgkmcnt(7)
    ds_read_b64_tr_b16 v[206:207], v11 offset:4416
    v_cvt_pk_bf16_f32 v231, v46, v47
    v_mfma_f32_16x16x32_bf16 v[20:23], v[164:167], v[128:131], v[48:51]
    ds_read_b64_tr_b16 v[208:209], v10 offset:128
    ds_read2st64_b32 v[244:245], v13 offset0:0 offset1:6
    v_mfma_f32_16x16x32_bf16 v[28:31], v[164:167], v[132:135], v[52:55]
    ds_read_b64_tr_b16 v[210:211], v10 offset:4480
    v_add_u32 v238, 1, v238
    v_mfma_f32_16x16x32_bf16 v[20:23], v[172:175], v[136:139], v[20:23]
    ds_read_b64_tr_b16 v[212:213], v11 offset:128
    v_exp_f32 v32, v16
    v_mfma_f32_16x16x32_bf16 v[28:31], v[172:175], v[140:143], v[28:31]
    ds_read_b64_tr_b16 v[214:215], v11 offset:4480
    v_exp_f32 v33, v17
    v_mfma_f32_16x16x32_bf16 v[20:23], v[180:183], v[144:147], v[20:23]
    ds_read_b64_tr_b16 v[216:217], v10 offset:192
    v_exp_f32 v34, v18
    v_mfma_f32_16x16x32_bf16 v[28:31], v[180:183], v[148:151], v[28:31]
    ds_read_b64_tr_b16 v[218:219], v10 offset:4544
    v_exp_f32 v35, v19
    v_mfma_f32_16x16x32_bf16 v[20:23], v[188:191], v[152:155], v[20:23]
    ds_read_b64_tr_b16 v[220:221], v11 offset:192
    v_exp_f32 v40, v24
    v_mfma_f32_16x16x32_bf16 v[28:31], v[188:191], v[156:159], v[28:31]
    s_waitcnt lgkmcnt(6)
    ds_read_b64_tr_b16 v[222:223], v11 offset:4544
    ds_write_b32 v14, v238
    v_mfma_f32_16x16x32_bf16 v[96:99], v[192:195], v[228:231], v[96:99]
    v_readfirstlane_b32 s71, v244
    v_add_u32 v9, s68, v6
    v_mfma_f32_16x16x32_bf16 v[64:67], v[192:195], v[224:227], v[64:67]
    v_exp_f32 v41, v25
    v_mfma_f32_16x16x32_bf16 v[100:103], v[196:199], v[228:231], v[100:103]
    s_cmp_lt_u32 s71, s73
    v_exp_f32 v42, v26
    v_mfma_f32_16x16x32_bf16 v[68:71], v[196:199], v[224:227], v[68:71]
    s_cbranch_scc1 L_slow
L_back:
    v_exp_f32 v43, v27
    v_mfma_f32_16x16x32_bf16 v[104:107], v[200:203], v[228:231], v[104:107]
    ds_read_b128 v[160:163], v9 offset:0
    v_max3_f32 v2, v16, v17, v18
    v_max3_f32 v2, v2, v19, v24
    v_mfma_f32_16x16x32_bf16 v[72:75], v[200:203], v[224:227], v[72:75]
    ds_read_b128 v[168:171], v9 offset:64
    v_exp_f32 v36, v20
    v_mfma_f32_16x16x32_bf16 v[108:111], v[204:207], v[228:231], v[108:111]
    ds_read_b128 v[176:179], v9 offset:128
    v_max3_f32 v2, v2, v25, v26
    v_max3_f32 v2, v2, v27, v20
    v_mfma_f32_16x16x32_bf16 v[76:79], v[204:207], v[224:227], v[76:79]
    v_exp_f32 v37, v21
    v_mfma_f32_16x16x32_bf16 v[56:59], v[232:235], v[224:227], v[56:59]
    ds_read_b128 v[184:187], v9 offset:192
    v_max3_f32 v2, v2, v21, v22
    v_max3_f32 v2, v2, v23, v28
    v_mfma_f32_16x16x32_bf16 v[60:63], v[232:235], v[228:231], v[60:63]
    s_waitcnt lgkmcnt(4)
    v_exp_f32 v38, v22
    v_mfma_f32_16x16x32_bf16 v[112:115], v[208:211], v[228:231], v[112:115]
    ds_read_b128 v[164:167], v9 offset:4352
    v_max3_f32 v2, v2, v29, v30
    v_max_f32 v2, v2, v31
    v_mfma_f32_16x16x32_bf16 v[80:83], v[208:211], v[224:227], v[80:83]
    v_exp_f32 v39, v23
    v_mfma_f32_16x16x32_bf16 v[116:119], v[212:215], v[228:231], v[116:119]
    ds_read_b128 v[172:175], v9 offset:4416
    v_cmp_lt_f32 vcc, s63, v2
    v_add_u32 v10, s68, v7
    v_mfma_f32_16x16x32_bf16 v[84:87], v[212:215], v[224:227], v[84:87]
    v_exp_f32 v44, v28
    v_mfma_f32_16x16x32_bf16 v[120:123], v[216:219], v[228:231], v[120:123]
    ds_read_b128 v[180:183], v9 offset:4480
    v_add_u32 v11, s68, v8
    v_mfma_f32_16x16x32_bf16 v[88:91], v[216:219], v[224:227], v[88:91]
    v_exp_f32 v45, v29
    v_mfma_f32_16x16x32_bf16 v[124:127], v[220:223], v[228:231], v[124:127]
    ds_read_b128 v[188:191], v9 offset:4544
    v_exp_f32 v46, v30
    v_mfma_f32_16x16x32_bf16 v[92:95], v[220:223], v[224:227], v[92:95]
    s_waitcnt lgkmcnt(4)
    v_exp_f32 v47, v31
    s_cbranch_vccz L_loop
    s_branch L_rare
L_slow:
    s_cmp_ge_i32 s80, 0
    s_cbranch_scc1 L_slow1
    v_readfirstlane_b32 s83, v245
    s_cmp_lt_u32 s71, s70
    s_cselect_b32 s73, 1, s69
    s_xor_b32 s74, s83, 1
    s_or_b32 s73, s73, s74
    s_cbranch_scc1 L_lastg
L_tail:
    ds_read_b32 v249, v247
    v_add_u32 v10, s68, v7
    v_add_u32 v11, s68, v8
    s_waitcnt lgkmcnt(1)
    ds_read_b64_tr_b16 v[160:161], v10 offset:0
    ds_read_b64_tr_b16 v[162:163], v10 offset:4352
    v_mfma_f32_16x16x32_bf16 v[104:107], v[200:203], v[228:231], v[104:107]
    ds_read_b64_tr_b16 v[164:165], v11 offset:0
    ds_read_b64_tr_b16 v[166:167], v11 offset:4352
    v_exp_f32 v43, v27
    v_max3_f32 v2, v16, v17, v18
    v_mfma_f32_16x16x32_bf16 v[108:111], v[204:207], v[228:231], v[108:111]
    ds_read_b64_tr_b16 v[168:169], v10 offset:64
    ds_read_b64_tr_b16 v[170:171], v10 offset:4416
    v_exp_f32 v44, v28
    v_max3_f32 v2, v2, v19, v24
    v_mfma_f32_16x16x32_bf16 v[112:115], v[208:211], v[228:231], v[112:115]
    ds_read_b64_tr_b16 v[172:173], v11 offset:64
    ds_read_b64_tr_b16 v[174:175], v11 offset:4416
    v_exp_f32 v45, v29
    v_max3_f32 v2, v2, v25, v26
    v_mfma_f32_16x16x32_bf16 v[116:119], v[212:215], v[228:231], v[116:119]
    ds_read_b64_tr_b16 v[176:177], v10 offset:128
    ds_read_b64_tr_b16 v[178:179], v10 offset:4480
    v_exp_f32 v46, v30
    v_max3_f32 v2, v2, v27, v20
    v_mfma_f32_16x16x32_bf16 v[120:123], v[216:219], v[228:231], v[120:123]
    ds_read_b64_tr_b16 v[180:181], v11 offset:128
    ds_read_b64_tr_b16 v[182:183], v11 offset:4480
    v_exp_f32 v47, v31
    v_max3_f32 v2, v2, v21, v22
    v_mfma_f32_16x16x32_bf16 v[124:127], v[220:223], v[228:231], v[124:127]
    ds_read_b64_tr_b16 v[184:185], v10 offset:192
    ds_read_b64_tr_b16 v[186:187], v10 offset:4544
    v_max3_f32 v2, v2, v23, v28
    v_max3_f32 v2, v2, v29, v30
    v_mfma_f32_16x16x32_bf16 v[60:63], v[232:235], v[228:231], v[60:63]
    ds_read_b64_tr_b16 v[188:189], v11 offset:192
    ds_read_b64_tr_b16 v[190:191], v11 offset:4544
    v_max_f32 v2, v2, v31
    v_cmp_lt_f32 vcc, s63, v2
    s_cbranch_vccnz L_tail_fix
    v_cvt_pk_bf16_f32 v228, v40, v41
    v_cvt_pk_bf16_f32 v229, v42, v43
    v_cvt_pk_bf16_f32 v230, v44, v45
    v_cvt_pk_bf16_f32 v231, v46, v47
    v_mfma_f32_16x16x32_bf16 v[72:75], v[200:203], v[224:227], v[72:75]
    v_exp_f32 v36, v20
    v_mfma_f32_16x16x32_bf16 v[60:63], v[232:235], v[228:231], v[60:63]
    s_waitcnt lgkmcnt(14)
    v_mfma_f32_16x16x32_bf16 v[96:99], v[160:163], v[228:231], v[96:99]
    s_waitcnt lgkmcnt(12)
    v_mfma_f32_16x16x32_bf16 v[100:103], v[164:167], v[228:231], v[100:103]
    s_waitcnt lgkmcnt(10)
    v_mfma_f32_16x16x32_bf16 v[104:107], v[168:171], v[228:231], v[104:107]
    s_waitcnt lgkmcnt(8)
    v_mfma_f32_16x16x32_bf16 v[108:111], v[172:175], v[228:231], v[108:111]
    s_waitcnt lgkmcnt(6)
    v_mfma_f32_16x16x32_bf16 v[112:115], v[176:179], v[228:231], v[112:115]
    v_mov_b32 v53, v60
    buffer_store_dwordx2 v[52:53], v243, s[20:23], s49 offen
    s_waitcnt lgkmcnt(4)
    v_mfma_f32_16x16x32_bf16 v[116:119], v[180:183], v[228:231], v[116:119]
    v_cvt_pk_bf16_f32 v144, v96, v97
    v_cvt_pk_bf16_f32 v145, v98, v99
    v_cvt_pk_bf16_f32 v146, v100, v101
    v_cvt_pk_bf16_f32 v147, v102, v103
    buffer_store_dwordx4 v[144:147], v239, s[24:27], s48 offen offset:0
    s_waitcnt lgkmcnt(2)
    v_mfma_f32_16x16x32_bf16 v[120:123], v[184:187], v[228:231], v[120:123]
    v_cvt_pk_bf16_f32 v148, v104, v105
    v_cvt_pk_bf16_f32 v149, v106, v107
    v_cvt_pk_bf16_f32 v150, v108, v109
    v_cvt_pk_bf16_f32 v151, v110, v111
    buffer_store_dwordx4 v[148:151], v239, s[24:27], s48 offen offset:1024
    s_waitcnt lgkmcnt(0)
    v_mfma_f32_16x16x32_bf16 v[124:127], v[188:191], v[228:231], v[124:127]
    v_cvt_pk_bf16_f32 v152, v112, v113
    v_cvt_pk_bf16_f32 v153, v114, v115
    v_cvt_pk_bf16_f32 v154, v116, v117
    v_cvt_pk_bf16_f32 v155, v118, v119
    buffer_store_dwordx4 v[152:155], v239, s[24:27], s48 offen offset:2048
    v_mfma_f32_16x16x32_bf16 v[76:79], v[204:207], v[224:227], v[76:79]
    v_exp_f32 v37, v21
    v_mfma_f32_16x16x32_bf16 v[80:83], v[208:211], v[224:227], v[80:83]
    v_exp_f32 v38, v22
    v_cvt_pk_bf16_f32 v156, v120, v121
    v_cvt_pk_bf16_f32 v157, v122, v123
    v_cvt_pk_bf16_f32 v158, v124, v125
    v_cvt_pk_bf16_f32 v159, v126, v127
    buffer_store_dwordx4 v[156:159], v239, s[24:27], s48 offen offset:3072
    v_mfma_f32_16x16x32_bf16 v[84:87], v[212:215], v[224:227], v[84:87]
    v_exp_f32 v39, v23
    v_mfma_f32_16x16x32_bf16 v[88:91], v[216:219], v[224:227], v[88:91]
    v_mfma_f32_16x16x32_bf16 v[92:95], v[220:223], v[224:227], v[92:95]
    v_mfma_f32_16x16x32_bf16 v[56:59], v[232:235], v[224:227], v[56:59]
    v_cvt_pk_bf16_f32 v224, v32, v33
    v_cvt_pk_bf16_f32 v225, v34, v35
    v_cvt_pk_bf16_f32 v226, v36, v37
    v_cvt_pk_bf16_f32 v227, v38, v39
    s_nop 1
    v_mfma_f32_16x16x32_bf16 v[56:59], v[232:235], v[224:227], v[56:59]
    v_mfma_f32_16x16x32_bf16 v[64:67], v[160:163], v[224:227], v[64:67]
    v_mfma_f32_16x16x32_bf16 v[68:71], v[164:167], v[224:227], v[68:71]
    v_mfma_f32_16x16x32_bf16 v[72:75], v[168:171], v[224:227], v[72:75]
    v_mfma_f32_16x16x32_bf16 v[76:79], v[172:175], v[224:227], v[76:79]
    v_mfma_f32_16x16x32_bf16 v[80:83], v[176:179], v[224:227], v[80:83]
    v_mfma_f32_16x16x32_bf16 v[84:87], v[180:183], v[224:227], v[84:87]
    v_mfma_f32_16x16x32_bf16 v[88:91], v[184:187], v[224:227], v[88:91]
    v_mfma_f32_16x16x32_bf16 v[92:95], v[188:191], v[224:227], v[92:95]
L_sent:
    v_add_u32 v250, 1, v249
    s_mov_b64 exec, 4
    s_waitcnt vmcnt(0)
    buffer_store_dword v250, v246, s[20:23], s50 offen
L_reld:
    s_mov_b64 exec, 3
    v_mov_b32 v251, v249
L_poll0:
    s_sub_u32 s46, s46, 1
    s_cbranch_scc1 L_end
    buffer_load_dword v251, v246, s[20:23], s50 offen sc1
    s_waitcnt vmcnt(1)
    v_cmp_eq_u32 vcc, v251, v249
    s_cbranch_vccnz L_poll0
    s_mov_b64 exec, -1
    buffer_load_dwordx2 v[252:253], v243, s[20:23], s54 offen sc1
    buffer_load_dwordx2 v[254:255], v243, s[20:23], s55 offen sc1
    buffer_load_dwordx4 v[144:147], v239, s[24:27], s56 offen offset:0 sc1
    buffer_load_dwordx4 v[148:151], v239, s[24:27], s56 offen offset:1024 sc1
    buffer_load_dwordx4 v[152:155], v239, s[24:27], s56 offen offset:2048 sc1
    buffer_load_dwordx4 v[156:159], v239, s[24:27], s56 offen offset:3072 sc1
    s_cmp_lg_u32 s42, 0
    s_cbranch_scc1 L_fin_held
    s_waitcnt vmcnt(4)
    v_min_f32 v2, v48, v252
    v_sub_f32 v4, v2, v48
    v_sub_f32 v236, v2, v252
    v_exp_f32 v4, v4
    v_exp_f32 v236, v236
    s_nop 0
    v_mul_f32 v3, v4, v56
    v_fmac_f32 v3, v236, v253
    v_rcp_f32 v3, v3
    s_nop 0
    v_mul_f32 v4, v4, v3
    v_mul_f32 v236, v236, v3
    v_pk_mul_f32 v[64:65], v[64:65], v[4:5] op_sel_hi:[1,0]
    v_pk_mul_f32 v[66:67], v[66:67], v[4:5] op_sel_hi:[1,0]
    v_pk_mul_f32 v[68:69], v[68:69], v[4:5] op_sel_hi:[1,0]
    v_pk_mul_f32 v[70:71], v[70:71], v[4:5] op_sel_hi:[1,0]
    v_pk_mul_f32 v[72:73], v[72:73], v[4:5] op_sel_hi:[1,0]
    v_pk_mul_f32 v[74:75], v[74:75], v[4:5] op_sel_hi:[1,0]
    v_pk_mul_f32 v[76:77], v[76:77], v[4:5] op_sel_hi:[1,0]
    v_pk_mul_f32 v[78:79], v[78:79], v[4:5] op_sel_hi:[1,0]
    v_pk_mul_f32 v[80:81], v[80:81], v[4:5] op_sel_hi:[1,0]
    v_pk_mul_f32 v[82:83], v[82:83], v[4:5] op_sel_hi:[1,0]
    v_pk_mul_f32 v[84:85], v[84:85], v[4:5] op_sel_hi:[1,0]
    v_pk_mul_f32 v[86:87], v[86:87], v[4:5] op_sel_hi:[1,0]
    v_pk_mul_f32 v[88:89], v[88:89], v[4:5] op_sel_hi:[1,0]
    v_pk_mul_f32 v[90:91], v[90:91], v[4:5] op_sel_hi:[1,0]
    v_pk_mul_f32 v[92:93], v[92:93], v[4:5] op_sel_hi:[1,0]
    v_pk_mul_f32 v[94:95], v[94:95], v[4:5] op_sel_hi:[1,0]
    s_waitcnt vmcnt(3)
    v_lshlrev_b32 v32, 16, v144
    v_and_b32 v33, 0xffff0000, v144
    v_lshlrev_b32 v34, 16, v145
    v_and_b32 v35, 0xffff0000, v145
    v_lshlrev_b32 v36, 16, v146
    v_and_b32 v37, 0xffff0000, v146
    v_lshlrev_b32 v38, 16, v147
    v_and_b32 v39, 0xffff0000, v147
    v_pk_fma_f32 v[64:65], v[32:33], v[236:237], v[64:65] op_sel_hi:[1,0,1]
    v_pk_fma_f32 v[66:67], v[34:35], v[236:237], v[66:67] op_sel_hi:[1,0,1]
    v_pk_fma_f32 v[68:69], v[36:37], v[236:237], v[68:69] op_sel_hi:[1,0,1]
    v_pk_fma_f32 v[70:71], v[38:39], v[236:237], v[70:71] op_sel_hi:[1,0,1]
    v_cvt_pk_bf16_f32 v160, v64, v65
    v_cvt_pk_bf16_f32 v161, v66, v67
    v_cvt_pk_bf16_f32 v162, v68, v69
    v_cvt_pk_bf16_f32 v163, v70, v71
    s_waitcnt vmcnt(0)
    v_lshlrev_b32 v32, 16, v148
    v_and_b32 v33, 0xffff0000, v148
    v_lshlrev_b32 v34, 16, v149
    v_and_b32 v35, 0xffff0000, v149
    v_lshlrev_b32 v36, 16, v150
    v_and_b32 v37, 0xffff0000, v150
    v_lshlrev_b32 v38, 16, v151
    v_and_b32 v39, 0xffff0000, v151
    v_pk_fma_f32 v[72:73], v[32:33], v[236:237], v[72:73] op_sel_hi:[1,0,1]
    v_pk_fma_f32 v[74:75], v[34:35], v[236:237], v[74:75] op_sel_hi:[1,0,1]
    v_pk_fma_f32 v[76:77], v[36:37], v[236:237], v[76:77] op_sel_hi:[1,0,1]
    v_pk_fma_f32 v[78:79], v[38:39], v[236:237], v[78:79] op_sel_hi:[1,0,1]
    v_permlane16_swap_b32 v160, v162
    v_permlane16_swap_b32 v161, v163
    buffer_store_dwordx4 v[160:163], v12, s[24:27], s51 offen offset:0
    v_cvt_pk_bf16_f32 v164, v72, v73
    v_cvt_pk_bf16_f32 v165, v74, v75
    v_cvt_pk_bf16_f32 v166, v76, v77
    v_cvt_pk_bf16_f32 v167, v78, v79
    v_lshlrev_b32 v32, 16, v152
    v_and_b32 v33, 0xffff0000, v152
    v_lshlrev_b32 v34, 16, v153
    v_and_b32 v35, 0xffff0000, v153
    v_lshlrev_b32 v36, 16, v154
    v_and_b32 v37, 0xffff0000, v154
    v_lshlrev_b32 v38, 16, v155
    v_and_b32 v39, 0xffff0000, v155
    v_pk_fma_f32 v[80:81], v[32:33], v[236:237], v[80:81] op_sel_hi:[1,0,1]
    v_pk_fma_f32 v[82:83], v[34:35], v[236:237], v[82:83] op_sel_hi:[1,0,1]
    v_pk_fma_f32 v[84:85], v[36:37], v[236:237], v[84:85] op_sel_hi:[1,0,1]
    v_pk_fma_f32 v[86:87], v[38:39], v[236:237], v[86:87] op_sel_hi:[1,0,1]
    v_permlane16_swap_b32 v164, v166
    v_permlane16_swap_b32 v165, v167
    buffer_store_dwordx4 v[164:167], v12, s[24:27], s51 offen offset:64
    v_cvt_pk_bf16_f32 v168, v80, v81
    v_cvt_pk_bf16_f32 v169, v82, v83
    v_cvt_pk_bf16_f32 v170, v84, v85
    v_cvt_pk_bf16_f32 v171, v86, v87
    v_lshlrev_b32 v32, 16, v156
    v_and_b32 v33, 0xffff0000, v156
    v_lshlrev_b32 v34, 16, v157
    v_and_b32 v35, 0xffff0000, v157
    v_lshlrev_b32 v36, 16, v158
    v_and_b32 v37, 0xffff0000, v158
    v_lshlrev_b32 v38, 16, v159
    v_and_b32 v39, 0xffff0000, v159
    v_pk_fma_f32 v[88:89], v[32:33], v[236:237], v[88:89] op_sel_hi:[1,0,1]
    v_pk_fma_f32 v[90:91], v[34:35], v[236:237], v[90:91] op_sel_hi:[1,0,1]
    v_pk_fma_f32 v[92:93], v[36:37], v[236:237], v[92:93] op_sel_hi:[1,0,1]
    v_pk_fma_f32 v[94:95], v[38:39], v[236:237], v[94:95] op_sel_hi:[1,0,1]
    v_permlane16_swap_b32 v168, v170
    v_permlane16_swap_b32 v169, v171
    buffer_store_dwordx4 v[168:171], v12, s[24:27], s51 offen offset:128
    v_cvt_pk_bf16_f32 v172, v88, v89
    v_cvt_pk_bf16_f32 v173, v90, v91
    v_cvt_pk_bf16_f32 v174, v92, v93
    v_cvt_pk_bf16_f32 v175, v94, v95
    s_nop 1
    v_permlane16_swap_b32 v172, v174
    v_permlane16_swap_b32 v173, v175
    buffer_store_dwordx4 v[172:175], v12, s[24:27], s51 offen offset:192
    s_endpgm
L_fin_held:
    buffer_load_dwordx4 v[128:131], v239, s[20:23], s57 offen offset:0 sc1
    buffer_load_dwordx4 v[132:135], v239, s[20:23], s57 offen offset:1024 sc1
    buffer_load_dwordx4 v[136:139], v239, s[20:23], s57 offen offset:2048 sc1
    buffer_load_dwordx4 v[140:143], v239, s[20:23], s57 offen offset:3072 sc1
    s_waitcnt vmcnt(8)
    v_min3_f32 v2, v48, v252, v254
    v_sub_f32 v4, v2, v48
    v_sub_f32 v236, v2, v252
    v_sub_f32 v237, v2, v254
    v_exp_f32 v4, v4
    v_exp_f32 v236, v236
    v_exp_f32 v237, v237
    v_mul_f32 v3, v4, v56
    v_fmac_f32 v3, v236, v253
    v_fmac_f32 v3, v237, v255
    v_rcp_f32 v3, v3
    s_nop 0
    v_mul_f32 v4, v4, v3
    v_mul_f32 v236, v236, v3
    v_mul_f32 v237, v237, v3
    v_pk_mul_f32 v[64:65], v[64:65], v[4:5] op_sel_hi:[1,0]
    v_pk_mul_f32 v[66:67], v[66:67], v[4:5] op_sel_hi:[1,0]
    v_pk_mul_f32 v[68:69], v[68:69], v[4:5] op_sel_hi:[1,0]
    v_pk_mul_f32 v[70:71], v[70:71], v[4:5] op_sel_hi:[1,0]
    v_pk_mul_f32 v[72:73], v[72:73], v[4:5] op_sel_hi:[1,0]
    v_pk_mul_f32 v[74:75], v[74:75], v[4:5] op_sel_hi:[1,0]
    v_pk_mul_f32 v[76:77], v[76:77], v[4:5] op_sel_hi:[1,0]
    v_pk_mul_f32 v[78:79], v[78:79], v[4:5] op_sel_hi:[1,0]
    v_pk_mul_f32 v[80:81], v[80:81], v[4:5] op_sel_hi:[1,0]
    v_pk_mul_f32 v[82:83], v[82:83], v[4:5] op_sel_hi:[1,0]
    v_pk_mul_f32 v[84:85], v[84:85], v[4:5] op_sel_hi:[1,0]
    v_pk_mul_f32 v[86:87], v[86:87], v[4:5] op_sel_hi:[1,0]
    v_pk_mul_f32 v[88:89], v[88:89], v[4:5] op_sel_hi:[1,0]
    v_pk_mul_f32 v[90:91], v[90:91], v[4:5] op_sel_hi:[1,0]
    v_pk_mul_f32 v[92:93], v[92:93], v[4:5] op_sel_hi:[1,0]
    v_pk_mul_f32 v[94:95], v[94:95], v[4:5] op_sel_hi:[1,0]
    s_waitcnt vmcnt(7)
    v_lshlrev_b32 v32, 16, v144
    v_and_b32 v33, 0xffff0000, v144
    v_lshlrev_b32 v34, 16, v145
    v_and_b32 v35, 0xffff0000, v145
    v_lshlrev_b32 v36, 16, v146
    v_and_b32 v37, 0xffff0000, v146
    v_lshlrev_b32 v38, 16, v147
    v_and_b32 v39, 0xffff0000, v147
    v_pk_fma_f32 v[64:65], v[32:33], v[236:237], v[64:65] op_sel_hi:[1,0,1]
    v_pk_fma_f32 v[66:67], v[34:35], v[236:237], v[66:67] op_sel_hi:[1,0,1]
    v_pk_fma_f32 v[68:69], v[36:37], v[236:237], v[68:69] op_sel_hi:[1,0,1]
    v_pk_fma_f32 v[70:71], v[38:39], v[236:237], v[70:71] op_sel_hi:[1,0,1]
    s_waitcnt vmcnt(6)
    v_lshlrev_b32 v32, 16, v148
    v_and_b32 v33, 0xffff0000, v148
    v_lshlrev_b32 v34, 16, v149
    v_and_b32 v35, 0xffff0000, v149
    v_lshlrev_b32 v36, 16, v150
    v_and_b32 v37, 0xffff0000, v150
    v_lshlrev_b32 v38, 16, v151
    v_and_b32 v39, 0xffff0000, v151
    v_pk_fma_f32 v[72:73], v[32:33], v[236:237], v[72:73] op_sel_hi:[1,0,1]
    v_pk_fma_f32 v[74:75], v[34:35], v[236:237], v[74:75] op_sel_hi:[1,0,1]
    v_pk_fma_f32 v[76:77], v[36:37], v[236:237], v[76:77] op_sel_hi:[1,0,1]
    v_pk_fma_f32 v[78:79], v[38:39], v[236:237], v[78:79] op_sel_hi:[1,0,1]
    s_waitcnt vmcnt(5)
    v_lshlrev_b32 v32, 16, v152
    v_and_b32 v33, 0xffff0000, v152
    v_lshlrev_b32 v34, 16, v153
    v_and_b32 v35, 0xffff0000, v153
    v_lshlrev_b32 v36, 16, v154
    v_and_b32 v37, 0xffff0000, v154
    v_lshlrev_b32 v38, 16, v155
    v_and_b32 v39, 0xffff0000, v155
    v_pk_fma_f32 v[80:81], v[32:33], v[236:237], v[80:81] op_sel_hi:[1,0,1]
    v_pk_fma_f32 v[82:83], v[34:35], v[236:237], v[82:83] op_sel_hi:[1,0,1]
    v_pk_fma_f32 v[84:85], v[36:37], v[236:237], v[84:85] op_sel_hi:[1,0,1]
    v_pk_fma_f32 v[86:87], v[38:39], v[236:237], v[86:87] op_sel_hi:[1,0,1]
    s_waitcnt vmcnt(4)
    v_lshlrev_b32 v32, 16, v156
    v_and_b32 v33, 0xffff0000, v156
    v_lshlrev_b32 v34, 16, v157
    v_and_b32 v35, 0xffff0000, v157
    v_lshlrev_b32 v36, 16, v158
    v_and_b32 v37, 0xffff0000, v158
    v_lshlrev_b32 v38, 16, v159
    v_and_b32 v39, 0xffff0000, v159
    v_pk_fma_f32 v[88:89], v[32:33], v[236:237], v[88:89] op_sel_hi:[1,0,1]
    v_pk_fma_f32 v[90:91], v[34:35], v[236:237], v[90:91] op_sel_hi:[1,0,1]
    v_pk_fma_f32 v[92:93], v[36:37], v[236:237], v[92:93] op_sel_hi:[1,0,1]
    v_pk_fma_f32 v[94:95], v[38:39], v[236:237], v[94:95] op_sel_hi:[1,0,1]
    s_waitcnt vmcnt(3)
    v_lshlrev_b32 v32, 16, v128
    v_and_b32 v33, 0xffff0000, v128
    v_lshlrev_b32 v34, 16, v129
    v_and_b32 v35, 0xffff0000, v129
    v_lshlrev_b32 v36, 16, v130
    v_and_b32 v37, 0xffff0000, v130
    v_lshlrev_b32 v38, 16, v131
    v_and_b32 v39, 0xffff0000, v131
    v_pk_fma_f32 v[64:65], v[32:33], v[236:237], v[64:65] op_sel:[0,1,0] op_sel_hi:[1,1,1]
    v_pk_fma_f32 v[66:67], v[34:35], v[236:237], v[66:67] op_sel:[0,1,0] op_sel_hi:[1,1,1]
    v_pk_fma_f32 v[68:69], v[36:37], v[236:237], v[68:69] op_sel:[0,1,0] op_sel_hi:[1,1,1]
    v_pk_fma_f32 v[70:71], v[38:39], v[236:237], v[70:71] op_sel:[0,1,0] op_sel_hi:[1,1,1]
    v_cvt_pk_bf16_f32 v160, v64, v65
    v_cvt_pk_bf16_f32 v161, v66, v67
    v_cvt_pk_bf16_f32 v162, v68, v69
    v_cvt_pk_bf16_f32 v163, v70, v71
    s_waitcnt vmcnt(0)
    v_lshlrev_b32 v32, 16, v132
    v_and_b32 v33, 0xffff0000, v132
    v_lshlrev_b32 v34, 16, v133
    v_and_b32 v35, 0xffff0000, v133
    v_lshlrev_b32 v36, 16, v134
    v_and_b32 v37, 0xffff0000, v134
    v_lshlrev_b32 v38, 16, v135
    v_and_b32 v39, 0xffff0000, v135
    v_pk_fma_f32 v[72:73], v[32:33], v[236:237], v[72:73] op_sel:[0,1,0] op_sel_hi:[1,1,1]
    v_pk_fma_f32 v[74:75], v[34:35], v[236:237], v[74:75] op_sel:[0,1,0] op_sel_hi:[1,1,1]
    v_pk_fma_f32 v[76:77], v[36:37], v[236:237], v[76:77] op_sel:[0,1,0] op_sel_hi:[1,1,1]
    v_pk_fma_f32 v[78:79], v[38:39], v[236:237], v[78:79] op_sel:[0,1,0] op_sel_hi:[1,1,1]
    v_permlane16_swap_b32 v160, v162
    v_permlane16_swap_b32 v161, v163
    buffer_store_dwordx4 v[160:163], v12, s[24:27], s51 offen offset:0
    v_cvt_pk_bf16_f32 v164, v72, v73
    v_cvt_pk_bf16_f32 v165, v74, v75
    v_cvt_pk_bf16_f32 v166, v76, v77
    v_cvt_pk_bf16_f32 v167, v78, v79
    v_lshlrev_b32 v32, 16, v136
    v_and_b32 v33, 0xffff0000, v136
    v_lshlrev_b32 v34, 16, v137
    v_and_b32 v35, 0xffff0000, v137
    v_lshlrev_b32 v36, 16, v138
    v_and_b32 v37, 0xffff0000, v138
    v_lshlrev_b32 v38, 16, v139
    v_and_b32 v39, 0xffff0000, v139
    v_pk_fma_f32 v[80:81], v[32:33], v[236:237], v[80:81] op_sel:[0,1,0] op_sel_hi:[1,1,1]
    v_pk_fma_f32 v[82:83], v[34:35], v[236:237], v[82:83] op_sel:[0,1,0] op_sel_hi:[1,1,1]
    v_pk_fma_f32 v[84:85], v[36:37], v[236:237], v[84:85] op_sel:[0,1,0] op_sel_hi:[1,1,1]
    v_pk_fma_f32 v[86:87], v[38:39], v[236:237], v[86:87] op_sel:[0,1,0] op_sel_hi:[1,1,1]
    v_permlane16_swap_b32 v164, v166
    v_permlane16_swap_b32 v165, v167
    buffer_store_dwordx4 v[164:167], v12, s[24:27], s51 offen offset:64
    v_cvt_pk_bf16_f32 v168, v80, v81
    v_cvt_pk_bf16_f32 v169, v82, v83
    v_cvt_pk_bf16_f32 v170, v84, v85
    v_cvt_pk_bf16_f32 v171, v86, v87
    v_lshlrev_b32 v32, 16, v140
    v_and_b32 v33, 0xffff0000, v140
    v_lshlrev_b32 v34, 16, v141
    v_and_b32 v35, 0xffff0000, v141
    v_lshlrev_b32 v36, 16, v142
    v_and_b32 v37, 0xffff0000, v142
    v_lshlrev_b32 v38, 16, v143
    v_and_b32 v39, 0xffff0000, v143
    v_pk_fma_f32 v[88:89], v[32:33], v[236:237], v[88:89] op_sel:[0,1,0] op_sel_hi:[1,1,1]
    v_pk_fma_f32 v[90:91], v[34:35], v[236:237], v[90:91] op_sel:[0,1,0] op_sel_hi:[1,1,1]
    v_pk_fma_f32 v[92:93], v[36:37], v[236:237], v[92:93] op_sel:[0,1,0] op_sel_hi:[1,1,1]
    v_pk_fma_f32 v[94:95], v[38:39], v[236:237], v[94:95] op_sel:[0,1,0] op_sel_hi:[1,1,1]
    v_permlane16_swap_b32 v168, v170
    v_permlane16_swap_b32 v169, v171
    buffer_store_dwordx4 v[168:171], v12, s[24:27], s51 offen offset:128
    v_cvt_pk_bf16_f32 v172, v88, v89
    v_cvt_pk_bf16_f32 v173, v90, v91
    v_cvt_pk_bf16_f32 v174, v92, v93
    v_cvt_pk_bf16_f32 v175, v94, v95
    s_nop 1
    v_permlane16_swap_b32 v172, v174
    v_permlane16_swap_b32 v173, v175
    buffer_store_dwordx4 v[172:175], v12, s[24:27], s51 offen offset:192
    s_endpgm
L_end:
    s_endpgm
L_lastg:
    v_exp_f32 v43, v27
    v_mfma_f32_16x16x32_bf16 v[104:107], v[200:203], v[228:231], v[104:107]
    v_max3_f32 v2, v16, v17, v18
    v_max3_f32 v2, v2, v19, v24
    v_mfma_f32_16x16x32_bf16 v[72:75], v[200:203], v[224:227], v[72:75]
    v_exp_f32 v36, v20
    v_mfma_f32_16x16x32_bf16 v[108:111], v[204:207], v[228:231], v[108:111]
    v_max3_f32 v2, v2, v25, v26
    v_max3_f32 v2, v2, v27, v20
    v_mfma_f32_16x16x32_bf16 v[76:79], v[204:207], v[224:227], v[76:79]
    v_exp_f32 v37, v21
    v_mfma_f32_16x16x32_bf16 v[56:59], v[232:235], v[224:227], v[56:59]
    v_max3_f32 v2, v2, v21, v22
    v_max3_f32 v2, v2, v23, v28
    v_mfma_f32_16x16x32_bf16 v[60:63], v[232:235], v[228:231], v[60:63]
    s_waitcnt lgkmcnt(0)
    v_exp_f32 v38, v22
    v_mfma_f32_16x16x32_bf16 v[112:115], v[208:211], v[228:231], v[112:115]
    v_max3_f32 v2, v2, v29, v30
    v_max_f32 v2, v2, v31
    v_mfma_f32_16x16x32_bf16 v[80:83], v[208:211], v[224:227], v[80:83]
    v_exp_f32 v39, v23
    v_mfma_f32_16x16x32_bf16 v[116:119], v[212:215], v[228:231], v[116:119]
    v_cmp_lt_f32 vcc, s63, v2
    v_add_u32 v10, s68, v7
    v_mfma_f32_16x16x32_bf16 v[84:87], v[212:215], v[224:227], v[84:87]
    v_exp_f32 v44, v28
    v_mfma_f32_16x16x32_bf16 v[120:123], v[216:219], v[228:231], v[120:123]
    v_add_u32 v11, s68, v8
    v_mfma_f32_16x16x32_bf16 v[88:91], v[216:219], v[224:227], v[88:91]
    v_exp_f32 v45, v29
    v_mfma_f32_16x16x32_bf16 v[124:127], v[220:223], v[228:231], v[124:127]
    v_exp_f32 v46, v30
    v_mfma_f32_16x16x32_bf16 v[92:95], v[220:223], v[224:227], v[92:95]
    s_waitcnt lgkmcnt(0)
    v_exp_f32 v47, v31
    s_cbranch_vccnz L_rare
L_final:
    ds_read2st64_b32 v[244:245], v13 offset0:0 offset1:6
    s_add_u32 s70, s67, 1
    s_mov_b32 s66, s67
    v_cvt_pk_bf16_f32 v224, v32, v33
    v_cvt_pk_bf16_f32 v225, v34, v35
    v_cvt_pk_bf16_f32 v226, v36, v37
    v_cvt_pk_bf16_f32 v227, v38, v39
    v_cvt_pk_bf16_f32 v228, v40, v41
    v_cvt_pk_bf16_f32 v229, v42, v43
    v_cvt_pk_bf16_f32 v230, v44, v45
    v_cvt_pk_bf16_f32 v231, v46, v47
    s_nop 0
    v_mfma_f32_16x16x32_bf16 v[56:59], v[232:235], v[224:227], v[56:59]
    v_mfma_f32_16x16x32_bf16 v[60:63], v[232:235], v[228:231], v[60:63]
    s_cmp_lg_u32 s69, 0
    s_cbranch_scc1 L_final_a
    s_waitcnt lgkmcnt(0)
    v_readfirstlane_b32 s71, v244
    v_readfirstlane_b32 s83, v245
    s_cmp_ge_u32 s71, s70
    s_cbranch_scc1 L_final1
L_spin_f:
    s_sub_u32 s46, s46, 1
    s_cbranch_scc1 L_end
    ds_read_b32 v15, v13 offset:0
    s_waitcnt lgkmcnt(0)
    v_readfirstlane_b32 s71, v15
    s_nop 0
    s_cmp_lt_u32 s71, s70
    s_cbranch_scc1 L_spin_f
L_final1:
    ds_read_b32 v249, v247
    ds_read_b64_tr_b16 v[192:193], v10 offset:0
    ds_read_b64_tr_b16 v[194:195], v10 offset:4352
    ds_read_b64_tr_b16 v[196:197], v11 offset:0
    ds_read_b64_tr_b16 v[198:199], v11 offset:4352
    ds_read_b64_tr_b16 v[200:201], v10 offset:64
    ds_read_b64_tr_b16 v[202:203], v10 offset:4416
    ds_read_b64_tr_b16 v[204:205], v11 offset:64
    ds_read_b64_tr_b16 v[206:207], v11 offset:4416
    ds_read_b64_tr_b16 v[208:209], v10 offset:128
    ds_read_b64_tr_b16 v[210:211], v10 offset:4480
    ds_read_b64_tr_b16 v[212:213], v11 offset:128
    ds_read_b64_tr_b16 v[214:215], v11 offset:4480
    ds_read_b64_tr_b16 v[216:217], v10 offset:192
    ds_read_b64_tr_b16 v[218:219], v10 offset:4544
    ds_read_b64_tr_b16 v[220:221], v11 offset:192
    ds_read_b64_tr_b16 v[222:223], v11 offset:4544
    s_cmp_eq_u32 s83, 1
    s_cbranch_scc1 L_final2
    v_mov_b32 v53, v60
    buffer_store_dwordx2 v[52:53], v243, s[20:23], s49 offen sc1
    s_waitcnt lgkmcnt(14)
    v_mfma_f32_16x16x32_bf16 v[96:99], v[192:195], v[228:231], v[96:99]
    s_waitcnt lgkmcnt(12)
    v_mfma_f32_16x16x32_bf16 v[100:103], v[196:199], v[228:231], v[100:103]
    s_waitcnt lgkmcnt(10)
    v_mfma_f32_16x16x32_bf16 v[104:107], v[200:203], v[228:231], v[104:107]
    s_waitcnt lgkmcnt(8)
    v_mfma_f32_16x16x32_bf16 v[108:111], v[204:207], v[228:231], v[108:111]
    s_waitcnt lgkmcnt(6)
    v_mfma_f32_16x16x32_bf16 v[112:115], v[208:211], v[228:231], v[112:115]
    s_waitcnt lgkmcnt(4)
    v_mfma_f32_16x16x32_bf16 v[116:119], v[212:215], v[228:231], v[116:119]
    v_cvt_pk_bf16_f32 v144, v96, v97
    v_cvt_pk_bf16_f32 v145, v98, v99
    v_cvt_pk_bf16_f32 v146, v100, v101
    v_cvt_pk_bf16_f32 v147, v102, v103
    buffer_store_dwordx4 v[144:147], v239, s[24:27], s48 offen offset:0 sc1
    s_waitcnt lgkmcnt(2)
    v_mfma_f32_16x16x32_bf16 v[120:123], v[216:219], v[228:231], v[120:123]
    v_cvt_pk_bf16_f32 v148, v104, v105
    v_cvt_pk_bf16_f32 v149, v106, v107
    v_cvt_pk_bf16_f32 v150, v108, v109
    v_cvt_pk_bf16_f32 v151, v110, v111
    buffer_store_dwordx4 v[148:151], v239, s[24:27], s48 offen offset:1024 sc1
    s_waitcnt lgkmcnt(0)
    v_mfma_f32_16x16x32_bf16 v[124:127], v[220:223], v[228:231], v[124:127]
    v_cvt_pk_bf16_f32 v152, v112, v113
    v_cvt_pk_bf16_f32 v153, v114, v115
    v_cvt_pk_bf16_f32 v154, v116, v117
    v_cvt_pk_bf16_f32 v155, v118, v119
    buffer_store_dwordx4 v[152:155], v239, s[24:27], s48 offen offset:2048 sc1
    v_mfma_f32_16x16x32_bf16 v[64:67], v[192:195], v[224:227], v[64:67]
    v_mfma_f32_16x16x32_bf16 v[68:71], v[196:199], v[224:227], v[68:71]
    v_mfma_f32_16x16x32_bf16 v[72:75], v[200:203], v[224:227], v[72:75]
    v_cvt_pk_bf16_f32 v156, v120, v121
    v_cvt_pk_bf16_f32 v157, v122, v123
    v_cvt_pk_bf16_f32 v158, v124, v125
    v_cvt_pk_bf16_f32 v159, v126, v127
    buffer_store_dwordx4 v[156:159], v239, s[24:27], s48 offen offset:3072 sc1
    v_mfma_f32_16x16x32_bf16 v[76:79], v[204:207], v[224:227], v[76:79]
    v_mfma_f32_16x16x32_bf16 v[80:83], v[208:211], v[224:227], v[80:83]
    v_mfma_f32_16x16x32_bf16 v[84:87], v[212:215], v[224:227], v[84:87]
    v_mfma_f32_16x16x32_bf16 v[88:91], v[216:219], v[224:227], v[88:91]
    v_mfma_f32_16x16x32_bf16 v[92:95], v[220:223], v[224:227], v[92:95]
    s_branch L_sentw
L_final2:
    v_mov_b32 v53, v60
    buffer_store_dwordx2 v[52:53], v243, s[20:23], s49 offen
    s_waitcnt lgkmcnt(14)
    v_mfma_f32_16x16x32_bf16 v[96:99], v[192:195], v[228:231], v[96:99]
    s_waitcnt lgkmcnt(12)
    v_mfma_f32_16x16x32_bf16 v[100:103], v[196:199], v[228:231], v[100:103]
    s_waitcnt lgkmcnt(10)
    v_mfma_f32_16x16x32_bf16 v[104:107], v[200:203], v[228:231], v[104:107]
    s_waitcnt lgkmcnt(8)
    v_mfma_f32_16x16x32_bf16 v[108:111], v[204:207], v[228:231], v[108:111]
    s_waitcnt lgkmcnt(6)
    v_mfma_f32_16x16x32_bf16 v[112:115], v[208:211], v[228:231], v[112:115]
    s_waitcnt lgkmcnt(4)
    v_mfma_f32_16x16x32_bf16 v[116:119], v[212:215], v[228:231], v[116:119]
    v_cvt_pk_bf16_f32 v144, v96, v97
    v_cvt_pk_bf16_f32 v145, v98, v99
    v_cvt_pk_bf16_f32 v146, v100, v101
    v_cvt_pk_bf16_f32 v147, v102, v103
    buffer_store_dwordx4 v[144:147], v239, s[24:27], s48 offen offset:0
    s_waitcnt lgkmcnt(2)
    v_mfma_f32_16x16x32_bf16 v[120:123], v[216:219], v[228:231], v[120:123]
    v_cvt_pk_bf16_f32 v148, v104, v105
    v_cvt_pk_bf16_f32 v149, v106, v107
    v_cvt_pk_bf16_f32 v150, v108, v109
    v_cvt_pk_bf16_f32 v151, v110, v111
    buffer_store_dwordx4 v[148:151], v239, s[24:27], s48 offen offset:1024
    s_waitcnt lgkmcnt(0)
    v_mfma_f32_16x16x32_bf16 v[124:127], v[220:223], v[228:231], v[124:127]
    v_cvt_pk_bf16_f32 v152, v112, v113
    v_cvt_pk_bf16_f32 v153, v114, v115
    v_cvt_pk_bf16_f32 v154, v116, v117
    v_cvt_pk_bf16_f32 v155, v118, v119
    buffer_store_dwordx4 v[152:155], v239, s[24:27], s48 offen offset:2048
    v_mfma_f32_16x16x32_bf16 v[64:67], v[192:195], v[224:227], v[64:67]
    v_mfma_f32_16x16x32_bf16 v[68:71], v[196:199], v[224:227], v[68:71]
    v_mfma_f32_16x16x32_bf16 v[72:75], v[200:203], v[224:227], v[72:75]
    v_cvt_pk_bf16_f32 v156, v120, v121
    v_cvt_pk_bf16_f32 v157, v122, v123
    v_cvt_pk_bf16_f32 v158, v124, v125
    v_cvt_pk_bf16_f32 v159, v126, v127
    buffer_store_dwordx4 v[156:159], v239, s[24:27], s48 offen offset:3072
    v_mfma_f32_16x16x32_bf16 v[76:79], v[204:207], v[224:227], v[76:79]
    v_mfma_f32_16x16x32_bf16 v[80:83], v[208:211], v[224:227], v[80:83]
    v_mfma_f32_16x16x32_bf16 v[84:87], v[212:215], v[224:227], v[84:87]
    v_mfma_f32_16x16x32_bf16 v[88:91], v[216:219], v[224:227], v[88:91]
    v_mfma_f32_16x16x32_bf16 v[92:95], v[220:223], v[224:227], v[92:95]
    s_branch L_sent
L_tail_fix:
    v_mfma_f32_16x16x32_bf16 v[72:75], v[200:203], v[224:227], v[72:75]
    v_mfma_f32_16x16x32_bf16 v[76:79], v[204:207], v[224:227], v[76:79]
    v_mfma_f32_16x16x32_bf16 v[80:83], v[208:211], v[224:227], v[80:83]
    v_mfma_f32_16x16x32_bf16 v[84:87], v[212:215], v[224:227], v[84:87]
    v_mfma_f32_16x16x32_bf16 v[88:91], v[216:219], v[224:227], v[88:91]
    v_mfma_f32_16x16x32_bf16 v[92:95], v[220:223], v[224:227], v[92:95]
    v_mfma_f32_16x16x32_bf16 v[56:59], v[232:235], v[224:227], v[56:59]
    s_branch L_rare
L_final_a:
L_spin_g:
    s_sub_u32 s46, s46, 1
    s_cbranch_scc1 L_end
    ds_read_b32 v15, v13 offset:0
    s_waitcnt lgkmcnt(0)
    v_readfirstlane_b32 s71, v15
    s_nop 0
    s_cmp_lt_u32 s71, s70
    s_cbranch_scc1 L_spin_g
    ds_read_b64_tr_b16 v[192:193], v10 offset:0
    ds_read_b64_tr_b16 v[194:195], v10 offset:4352
    ds_read_b64_tr_b16 v[196:197], v11 offset:0
    ds_read_b64_tr_b16 v[198:199], v11 offset:4352
    ds_read_b64_tr_b16 v[200:201], v10 offset:64
    ds_read_b64_tr_b16 v[202:203], v10 offset:4416
    ds_read_b64_tr_b16 v[204:205], v11 offset:64
    ds_read_b64_tr_b16 v[206:207], v11 offset:4416
    ds_read_b64_tr_b16 v[208:209], v10 offset:128
    ds_read_b64_tr_b16 v[210:211], v10 offset:4480
    ds_read_b64_tr_b16 v[212:213], v11 offset:128
    ds_read_b64_tr_b16 v[214:215], v11 offset:4480
    ds_read_b64_tr_b16 v[216:217], v10 offset:192
    ds_read_b64_tr_b16 v[218:219], v10 offset:4544
    ds_read_b64_tr_b16 v[220:221], v11 offset:192
    ds_read_b64_tr_b16 v[222:223], v11 offset:4544
    s_waitcnt lgkmcnt(14)
    v_mfma_f32_16x16x32_bf16 v[96:99], v[192:195], v[228:231], v[96:99]
    v_mfma_f32_16x16x32_bf16 v[64:67], v[192:195], v[224:227], v[64:67]
    s_waitcnt lgkmcnt(12)
    v_mfma_f32_16x16x32_bf16 v[100:103], v[196:199], v[228:231], v[100:103]
    v_mfma_f32_16x16x32_bf16 v[68:71], v[196:199], v[224:227], v[68:71]
    s_waitcnt lgkmcnt(10)
    v_mfma_f32_16x16x32_bf16 v[104:107], v[200:203], v[228:231], v[104:107]
    v_mfma_f32_16x16x32_bf16 v[72:75], v[200:203], v[224:227], v[72:75]
    s_waitcnt lgkmcnt(8)
    v_mfma_f32_16x16x32_bf16 v[108:111], v[204:207], v[228:231], v[108:111]
    v_mfma_f32_16x16x32_bf16 v[76:79], v[204:207], v[224:227], v[76:79]
    s_waitcnt lgkmcnt(6)
    v_mfma_f32_16x16x32_bf16 v[112:115], v[208:211], v[228:231], v[112:115]
    v_mfma_f32_16x16x32_bf16 v[80:83], v[208:211], v[224:227], v[80:83]
    s_waitcnt lgkmcnt(4)
    v_mfma_f32_16x16x32_bf16 v[116:119], v[212:215], v[228:231], v[116:119]
    v_mfma_f32_16x16x32_bf16 v[84:87], v[212:215], v[224:227], v[84:87]
    s_waitcnt lgkmcnt(2)
    v_mfma_f32_16x16x32_bf16 v[120:123], v[216:219], v[228:231], v[120:123]
    v_mfma_f32_16x16x32_bf16 v[88:91], v[216:219], v[224:227], v[88:91]
    s_waitcnt lgkmcnt(0)
    v_mfma_f32_16x16x32_bf16 v[124:127], v[220:223], v[228:231], v[124:127]
    v_mfma_f32_16x16x32_bf16 v[92:95], v[220:223], v[224:227], v[92:95]
    s_branch L_segB
L_sentw:
    v_mov_b32 v2, 159232
L_peers:
    s_sub_u32 s46, s46, 1
    s_cbranch_scc1 L_end
    ds_read_b32 v15, v2
    ds_read_b32 v249, v247
    s_waitcnt lgkmcnt(0)
    v_readfirstlane_b32 s73, v15
    s_nop 0
    s_cmp_eq_u32 s73, 0
    s_cbranch_scc1 L_peers
    v_add_u32 v250, 1, v249
    s_mov_b64 exec, 4
    s_waitcnt vmcnt(0)
    buffer_store_dword v250, v246, s[20:23], s50 offen sc1
    s_branch L_reld
L_hold:
L_spin_q:
    s_sub_u32 s46, s46, 1
    s_cbranch_scc1 L_end
    ds_read_b32 v15, v13 offset:256
    s_waitcnt lgkmcnt(0)
    v_readfirstlane_b32 s71, v15
    s_nop 0
    s_cmp_le_u32 s71, s82
    s_cbranch_scc1 L_spin_q
    ds_read_b128 v[128:131], v9 offset:0
    ds_read_b128 v[132:135], v9 offset:4352
    ds_read_b128 v[136:139], v9 offset:64
    ds_read_b128 v[140:143], v9 offset:4416
    ds_read_b128 v[144:147], v9 offset:128
    ds_read_b128 v[148:151], v9 offset:4480
    ds_read_b128 v[152:155], v9 offset:192
    ds_read_b128 v[156:159], v9 offset:4544
    v_add_u32 v4, s81, v239
    v_add_u32 v5, s81, v243
    v_mov_b32 v49, v56
    v_mov_b32 v53, v60
    ds_write_b64 v5, v[48:49] offset:8192
    ds_write_b64 v5, v[52:53] offset:8320
    v_cvt_pk_bf16_f32 v160, v64, v65
    v_cvt_pk_bf16_f32 v161, v66, v67
    v_cvt_pk_bf16_f32 v162, v68, v69
    v_cvt_pk_bf16_f32 v163, v70, v71
    ds_write_b128 v4, v[160:163] offset:0
    v_cvt_pk_bf16_f32 v164, v72, v73
    v_cvt_pk_bf16_f32 v165, v74, v75
    v_cvt_pk_bf16_f32 v166, v76, v77
    v_cvt_pk_bf16_f32 v167, v78, v79
    ds_write_b128 v4, v[164:167] offset:1024
    v_cvt_pk_bf16_f32 v168, v80, v81
    v_cvt_pk_bf16_f32 v169, v82, v83
    v_cvt_pk_bf16_f32 v170, v84, v85
    v_cvt_pk_bf16_f32 v171, v86, v87
    ds_write_b128 v4, v[168:171] offset:2048
    v_cvt_pk_bf16_f32 v172, v88, v89
    v_cvt_pk_bf16_f32 v173, v90, v91
    v_cvt_pk_bf16_f32 v174, v92, v93
    v_cvt_pk_bf16_f32 v175, v94, v95
    ds_write_b128 v4, v[172:175] offset:3072
    v_cvt_pk_bf16_f32 v176, v96, v97
    v_cvt_pk_bf16_f32 v177, v98, v99
    v_cvt_pk_bf16_f32 v178, v100, v101
    v_cvt_pk_bf16_f32 v179, v102, v103
    ds_write_b128 v4, v[176:179] offset:4096
    v_cvt_pk_bf16_f32 v180, v104, v105
    v_cvt_pk_bf16_f32 v181, v106, v107
    v_cvt_pk_bf16_f32 v182, v108, v109
    v_cvt_pk_bf16_f32 v183, v110, v111
    ds_write_b128 v4, v[180:183] offset:5120
    v_cvt_pk_bf16_f32 v184, v112, v113
    v_cvt_pk_bf16_f32 v185, v114, v115
    v_cvt_pk_bf16_f32 v186, v116, v117
    v_cvt_pk_bf16_f32 v187, v118, v119
    ds_write_b128 v4, v[184:187] offset:6144
    v_cvt_pk_bf16_f32 v188, v120, v121
    v_cvt_pk_bf16_f32 v189, v122, v123
    v_cvt_pk_bf16_f32 v190, v124, v125
    v_cvt_pk_bf16_f32 v191, v126, v127
    ds_write_b128 v4, v[188:191] offset:7168
    v_mov_b32 v56, 0
    v_mov_b32 v57, 0
    v_mov_b32 v58, 0
    v_mov_b32 v59, 0
    v_mov_b32 v60, 0
    v_mov_b32 v61, 0
    v_mov_b32 v62, 0
    v_mov_b32 v63, 0
    v_mov_b32 v64, 0
    v_mov_b32 v65, 0
    v_mov_b32 v66, 0
    v_mov_b32 v67, 0
    v_mov_b32 v68, 0
    v_mov_b32 v69, 0
    v_mov_b32 v70, 0
    v_mov_b32 v71, 0
    v_mov_b32 v72, 0
    v_mov_b32 v73, 0
    v_mov_b32 v74, 0
    v_mov_b32 v75, 0
    v_mov_b32 v76, 0
    v_mov_b32 v77, 0
    v_mov_b32 v78, 0
    v_mov_b32 v79, 0
    v_mov_b32 v80, 0
    v_mov_b32 v81, 0
    v_mov_b32 v82, 0
    v_mov_b32 v83, 0
    v_mov_b32 v84, 0
    v_mov_b32 v85, 0
    v_mov_b32 v86, 0
    v_mov_b32 v87, 0
    v_mov_b32 v88, 0
    v_mov_b32 v89, 0
    v_mov_b32 v90, 0
    v_mov_b32 v91, 0
    v_mov_b32 v92, 0
    v_mov_b32 v93, 0
    v_mov_b32 v94, 0
    v_mov_b32 v95, 0
    v_mov_b32 v96, 0
    v_mov_b32 v97, 0
    v_mov_b32 v98, 0
    v_mov_b32 v99, 0
    v_mov_b32 v100, 0
    v_mov_b32 v101, 0
    v_mov_b32 v102, 0
    v_mov_b32 v103, 0
    v_mov_b32 v104, 0
    v_mov_b32 v105, 0
    v_mov_b32 v106, 0
    v_mov_b32 v107, 0
    v_mov_b32 v108, 0
    v_mov_b32 v109, 0
    v_mov_b32 v110, 0
    v_mov_b32 v111, 0
    v_mov_b32 v112, 0
    v_mov_b32 v113, 0
    v_mov_b32 v114, 0
    v_mov_b32 v115, 0
    v_mov_b32 v116, 0
    v_mov_b32 v117, 0
    v_mov_b32 v118, 0
    v_mov_b32 v119, 0
    v_mov_b32 v120, 0
    v_mov_b32 v121, 0
    v_mov_b32 v122, 0
    v_mov_b32 v123, 0
    v_mov_b32 v124, 0
    v_mov_b32 v125, 0
    v_mov_b32 v126, 0
    v_mov_b32 v127, 0
    s_branch L_nohold
L_empty:
    s_cmp_eq_u32 s66, 0
    s_cbranch_scc1 L_empty1
    s_nop 5
    v_add_u32 v4, s81, v239
    v_add_u32 v5, s81, v243
    v_mov_b32 v49, v56
    v_mov_b32 v53, v60
    ds_write_b64 v5, v[48:49] offset:8192
    ds_write_b64 v5, v[52:53] offset:8320
    v_cvt_pk_bf16_f32 v160, v64, v65
    v_cvt_pk_bf16_f32 v161, v66, v67
    v_cvt_pk_bf16_f32 v162, v68, v69
    v_cvt_pk_bf16_f32 v163, v70, v71
    ds_write_b128 v4, v[160:163] offset:0
    v_cvt_pk_bf16_f32 v164, v72, v73
    v_cvt_pk_bf16_f32 v165, v74, v75
    v_cvt_pk_bf16_f32 v166, v76, v77
    v_cvt_pk_bf16_f32 v167, v78, v79
    ds_write_b128 v4, v[164:167] offset:1024
    v_cvt_pk_bf16_f32 v168, v80, v81
    v_cvt_pk_bf16_f32 v169, v82, v83
    v_cvt_pk_bf16_f32 v170, v84, v85
    v_cvt_pk_bf16_f32 v171, v86, v87
    ds_write_b128 v4, v[168:171] offset:2048
    v_cvt_pk_bf16_f32 v172, v88, v89
    v_cvt_pk_bf16_f32 v173, v90, v91
    v_cvt_pk_bf16_f32 v174, v92, v93
    v_cvt_pk_bf16_f32 v175, v94, v95
    ds_write_b128 v4, v[172:175] offset:3072
    v_cvt_pk_bf16_f32 v176, v96, v97
    v_cvt_pk_bf16_f32 v177, v98, v99
    v_cvt_pk_bf16_f32 v178, v100, v101
    v_cvt_pk_bf16_f32 v179, v102, v103
    ds_write_b128 v4, v[176:179] offset:4096
    v_cvt_pk_bf16_f32 v180, v104, v105
    v_cvt_pk_bf16_f32 v181, v106, v107
    v_cvt_pk_bf16_f32 v182, v108, v109
    v_cvt_pk_bf16_f32 v183, v110, v111
    ds_write_b128 v4, v[180:183] offset:5120
    v_cvt_pk_bf16_f32 v184, v112, v113
    v_cvt_pk_bf16_f32 v185, v114, v115
    v_cvt_pk_bf16_f32 v186, v116, v117
    v_cvt_pk_bf16_f32 v187, v118, v119
    ds_write_b128 v4, v[184:187] offset:6144
    v_cvt_pk_bf16_f32 v188, v120, v121
    v_cvt_pk_bf16_f32 v189, v122, v123
    v_cvt_pk_bf16_f32 v190, v124, v125
    v_cvt_pk_bf16_f32 v191, v126, v127
    ds_write_b128 v4, v[188:191] offset:7168
    v_mov_b32 v56, 0
    v_mov_b32 v57, 0
    v_mov_b32 v58, 0
    v_mov_b32 v59, 0
    v_mov_b32 v60, 0
    v_mov_b32 v61, 0
    v_mov_b32 v62, 0
    v_mov_b32 v63, 0
    v_mov_b32 v64, 0
    v_mov_b32 v65, 0
    v_mov_b32 v66, 0
    v_mov_b32 v67, 0
    v_mov_b32 v68, 0
    v_mov_b32 v69, 0
    v_mov_b32 v70, 0
    v_mov_b32 v71, 0
    v_mov_b32 v72, 0
    v_mov_b32 v73, 0
    v_mov_b32 v74, 0
    v_mov_b32 v75, 0
    v_mov_b32 v76, 0
    v_mov_b32 v77, 0
    v_mov_b32 v78, 0
    v_mov_b32 v79, 0
    v_mov_b32 v80, 0
    v_mov_b32 v81, 0
    v_mov_b32 v82, 0
    v_mov_b32 v83, 0
    v_mov_b32 v84, 0
    v_mov_b32 v85, 0
    v_mov_b32 v86, 0
    v_mov_b32 v87, 0
    v_mov_b32 v88, 0
    v_mov_b32 v89, 0
    v_mov_b32 v90, 0
    v_mov_b32 v91, 0
    v_mov_b32 v92, 0
    v_mov_b32 v93, 0
    v_mov_b32 v94, 0
    v_mov_b32 v95, 0
    v_mov_b32 v96, 0
    v_mov_b32 v97, 0
    v_mov_b32 v98, 0
    v_mov_b32 v99, 0
    v_mov_b32 v100, 0
    v_mov_b32 v101, 0
    v_mov_b32 v102, 0
    v_mov_b32 v103, 0
    v_mov_b32 v104, 0
    v_mov_b32 v105, 0
    v_mov_b32 v106, 0
    v_mov_b32 v107, 0
    v_mov_b32 v108, 0
    v_mov_b32 v109, 0
    v_mov_b32 v110, 0
    v_mov_b32 v111, 0
    v_mov_b32 v112, 0
    v_mov_b32 v113, 0
    v_mov_b32 v114, 0
    v_mov_b32 v115, 0
    v_mov_b32 v116, 0
    v_mov_b32 v117, 0
    v_mov_b32 v118, 0
    v_mov_b32 v119, 0
    v_mov_b32 v120, 0
    v_mov_b32 v121, 0
    v_mov_b32 v122, 0
    v_mov_b32 v123, 0
    v_mov_b32 v124, 0
    v_mov_b32 v125, 0
    v_mov_b32 v126, 0
    v_mov_b32 v127, 0
    v_add_u32 v241, 1, v241
    ds_write_b32 v14, v241 offset:1536
L_empty1:
    v_mov_b32 v48, 0x7149f2ca
    v_mov_b32 v52, 0x7149f2ca
    s_waitcnt vmcnt(0)
    v_mov_b32 v53, v60
    buffer_store_dwordx2 v[52:53], v243, s[20:23], s49 offen sc1
    v_cvt_pk_bf16_f32 v144, v96, v97
    v_cvt_pk_bf16_f32 v145, v98, v99
    v_cvt_pk_bf16_f32 v146, v100, v101
    v_cvt_pk_bf16_f32 v147, v102, v103
    buffer_store_dwordx4 v[144:147], v239, s[24:27], s48 offen offset:0 sc1
    v_cvt_pk_bf16_f32 v148, v104, v105
    v_cvt_pk_bf16_f32 v149, v106, v107
    v_cvt_pk_bf16_f32 v150, v108, v109
    v_cvt_pk_bf16_f32 v151, v110, v111
    buffer_store_dwordx4 v[148:151], v239, s[24:27], s48 offen offset:1024 sc1
    v_cvt_pk_bf16_f32 v152, v112, v113
    v_cvt_pk_bf16_f32 v153, v114, v115
    v_cvt_pk_bf16_f32 v154, v116, v117
    v_cvt_pk_bf16_f32 v155, v118, v119
    buffer_store_dwordx4 v[152:155], v239, s[24:27], s48 offen offset:2048 sc1
    v_cvt_pk_bf16_f32 v156, v120, v121
    v_cvt_pk_bf16_f32 v157, v122, v123
    v_cvt_pk_bf16_f32 v158, v124, v125
    v_cvt_pk_bf16_f32 v159, v126, v127
    buffer_store_dwordx4 v[156:159], v239, s[24:27], s48 offen offset:3072 sc1
    s_branch L_sentw
L_slow1:
    s_branch L_slow2
L_slow3:
    s_sleep 4
L_slow2:
    s_sub_u32 s46, s46, 1
    s_cbranch_scc1 L_end
    ds_read_b32 v15, v13
    s_waitcnt lgkmcnt(0)
    v_readfirstlane_b32 s71, v15
    s_nop 0
    s_cmp_lt_u32 s71, s70
    s_cbranch_scc1 L_slow3
    s_branch L_back
L_rare:
    v_max3_f32 v236, v16, v17, v18
    v_max3_f32 v237, v24, v25, v26
    v_max3_f32 v236, v236, v19, v20
    v_max3_f32 v237, v237, v27, v28
    v_max3_f32 v236, v236, v21, v22
    v_max3_f32 v237, v237, v29, v30
    v_max_f32 v236, v236, v23
    v_max_f32 v237, v237, v31
    v_mov_b32 v2, v236
    v_mov_b32 v3, v237
    s_nop 0
    v_permlane32_swap_b32 v236, v2
    v_permlane32_swap_b32 v237, v3
    s_nop 0
    v_max_f32 v236, v236, v2
    v_max_f32 v237, v237, v3
    v_mov_b32 v2, v236
    v_mov_b32 v3, v237
    s_nop 0
    v_permlane16_swap_b32 v236, v2
    v_permlane16_swap_b32 v237, v3
    s_nop 0
    v_max_f32 v236, v236, v2
    v_max_f32 v237, v237, v3
    v_max_f32 v236, 0, v236
    v_max_f32 v237, 0, v237
    v_ceil_f32 v236, v236
    v_ceil_f32 v237, v237
    v_exp_f32 v4, -v236
    v_exp_f32 v5, -v237
    v_sub_f32 v48, v48, v236
    v_sub_f32 v49, v49, v236
    v_sub_f32 v50, v50, v236
    v_sub_f32 v51, v51, v236
    v_sub_f32 v52, v52, v237
    v_sub_f32 v53, v53, v237
    v_sub_f32 v54, v54, v237
    v_sub_f32 v55, v55, v237
    v_sub_f32 v32, v16, v236
    v_sub_f32 v33, v17, v236
    v_sub_f32 v34, v18, v236
    v_sub_f32 v35, v19, v236
    v_sub_f32 v36, v20, v236
    v_sub_f32 v37, v21, v236
    v_sub_f32 v38, v22, v236
    v_sub_f32 v39, v23, v236
    v_sub_f32 v40, v24, v237
    v_sub_f32 v41, v25, v237
    v_sub_f32 v42, v26, v237
    v_sub_f32 v43, v27, v237
    v_sub_f32 v44, v28, v237
    v_sub_f32 v45, v29, v237
    v_sub_f32 v46, v30, v237
    v_sub_f32 v47, v31, v237
    v_exp_f32 v32, v32
    v_exp_f32 v33, v33
    v_exp_f32 v34, v34
    v_exp_f32 v35, v35
    v_exp_f32 v36, v36
    v_exp_f32 v37, v37
    v_exp_f32 v38, v38
    v_exp_f32 v39, v39
    v_exp_f32 v40, v40
    v_exp_f32 v41, v41
    v_exp_f32 v42, v42
    v_exp_f32 v43, v43
    v_exp_f32 v44, v44
    v_exp_f32 v45, v45
    v_exp_f32 v46, v46
    v_exp_f32 v47, v47
    v_pk_mul_f32 v[64:65], v[64:65], v[4:5] op_sel_hi:[1,0]
    v_pk_mul_f32 v[66:67], v[66:67], v[4:5] op_sel_hi:[1,0]
    v_pk_mul_f32 v[68:69], v[68:69], v[4:5] op_sel_hi:[1,0]
    v_pk_mul_f32 v[70:71], v[70:71], v[4:5] op_sel_hi:[1,0]
    v_pk_mul_f32 v[72:73], v[72:73], v[4:5] op_sel_hi:[1,0]
    v_pk_mul_f32 v[74:75], v[74:75], v[4:5] op_sel_hi:[1,0]
    v_pk_mul_f32 v[76:77], v[76:77], v[4:5] op_sel_hi:[1,0]
    v_pk_mul_f32 v[78:79], v[78:79], v[4:5] op_sel_hi:[1,0]
    v_pk_mul_f32 v[80:81], v[80:81], v[4:5] op_sel_hi:[1,0]
    v_pk_mul_f32 v[82:83], v[82:83], v[4:5] op_sel_hi:[1,0]
    v_pk_mul_f32 v[84:85], v[84:85], v[4:5] op_sel_hi:[1,0]
    v_pk_mul_f32 v[86:87], v[86:87], v[4:5] op_sel_hi:[1,0]
    v_pk_mul_f32 v[88:89], v[88:89], v[4:5] op_sel_hi:[1,0]
    v_pk_mul_f32 v[90:91], v[90:91], v[4:5] op_sel_hi:[1,0]
    v_pk_mul_f32 v[92:93], v[92:93], v[4:5] op_sel_hi:[1,0]
    v_pk_mul_f32 v[94:95], v[94:95], v[4:5] op_sel_hi:[1,0]
    v_mul_f32 v56, v4, v56
    v_pk_mul_f32 v[96:97], v[96:97], v[4:5] op_sel:[0,1] op_sel_hi:[1,1]
    v_pk_mul_f32 v[98:99], v[98:99], v[4:5] op_sel:[0,1] op_sel_hi:[1,1]
    v_pk_mul_f32 v[100:101], v[100:101], v[4:5] op_sel:[0,1] op_sel_hi:[1,1]
    v_pk_mul_f32 v[102:103], v[102:103], v[4:5] op_sel:[0,1] op_sel_hi:[1,1]
    v_pk_mul_f32 v[104:105], v[104:105], v[4:5] op_sel:[0,1] op_sel_hi:[1,1]
    v_pk_mul_f32 v[106:107], v[106:107], v[4:5] op_sel:[0,1] op_sel_hi:[1,1]
    v_pk_mul_f32 v[108:109], v[108:109], v[4:5] op_sel:[0,1] op_sel_hi:[1,1]
    v_pk_mul_f32 v[110:111], v[110:111], v[4:5] op_sel:[0,1] op_sel_hi:[1,1]
    v_pk_mul_f32 v[112:113], v[112:113], v[4:5] op_sel:[0,1] op_sel_hi:[1,1]
    v_pk_mul_f32 v[114:115], v[114:115], v[4:5] op_sel:[0,1] op_sel_hi:[1,1]
    v_pk_mul_f32 v[116:117], v[116:117], v[4:5] op_sel:[0,1] op_sel_hi:[1,1]
    v_pk_mul_f32 v[118:119], v[118:119], v[4:5] op_sel:[0,1] op_sel_hi:[1,1]
    v_pk_mul_f32 v[120:121], v[120:121], v[4:5] op_sel:[0,1] op_sel_hi:[1,1]
    v_pk_mul_f32 v[122:123], v[122:123], v[4:5] op_sel:[0,1] op_sel_hi:[1,1]
    v_pk_mul_f32 v[124:125], v[124:125], v[4:5] op_sel:[0,1] op_sel_hi:[1,1]
    v_pk_mul_f32 v[126:127], v[126:127], v[4:5] op_sel:[0,1] op_sel_hi:[1,1]
    v_mul_f32 v60, v5, v60
    s_cmp_lt_i32 s80, 0
    s_cbranch_scc1 L_final
    s_branch L_loop
L_code_end:
.section .rodata,"a"
.p2align 6
.amdhsa_kernel standalone__paged_block_table_kv_pagedattention__sampling_kernel
      .amdhsa_next_free_vgpr 256
      .amdhsa_next_free_sgpr 102
      .amdhsa_accum_offset 256
      .amdhsa_group_segment_fixed_size 0
      .amdhsa_kernarg_size 64
      .amdhsa_user_sgpr_count 2
      .amdhsa_user_sgpr_kernarg_segment_ptr 1
      .amdhsa_system_sgpr_workgroup_id_x 1
.end_amdhsa_kernel
```
